```python
import torch

def _softmax(x, axis=-1):
    return torch.softmax(x, dim=axis)
def _gelu(x):
    return torch.nn.functional.gelu(x, approximate="tanh")
def _silu(x):
    return torch.nn.functional.silu(x)
def _sigmoid(x):
    return torch.sigmoid(x)
def _layernorm(x, axis=-1, eps=1e-5):
    m = x.mean(dim=axis, keepdim=True)
    v = x.var(dim=axis, keepdim=True, unbiased=False)
    return (x - m) / torch.sqrt(v + eps)
def _scatter_add(tgt, idx, src, axis=0):
    return tgt.clone().index_add_(axis, idx, src)
def _segment_sum(src, seg, n):
    out = torch.zeros((n,) + src.shape[1:], dtype=src.dtype)
    return out.index_add_(0, seg, src)
def _pad(x, pw):
    flat = tuple(v for pair in reversed(pw) for v in pair)
    return torch.nn.functional.pad(x, flat)

kernel_name = 'concat_heads__gqa_block_cached__gqa_block_cached__near_ridge'

def setup_inputs():

    _w = (lambda a: (lambda t: t.to(torch.bfloat16) if t.is_floating_point() else t)(torch.as_tensor(a)))
    def _A_setup():
        B, Sq, D = 8, 80, 512
        Hq, Hkv, Sk, Dh = 32, 8, 2048, 128
        assert Hq % Hkv == 0, (Hq, Hkv)
        return {
            "x": _w((lambda *s: torch.randn(*s, dtype=torch.bfloat16) * 0.8)(B, Sq, D)),
            "k_cache": _w((lambda *s: torch.randn(*s, dtype=torch.bfloat16) * 0.8)(B, Hkv, Sk, Dh)),
            "v_cache": _w((lambda *s: torch.randn(*s, dtype=torch.bfloat16) * 0.05)(B, Hkv, Sk, Dh)),
            "wq": _w((lambda *s: torch.randn(*s, dtype=torch.bfloat16) * 0.8)(D, Hq * Dh) * (D ** -0.5)),
            "wo": _w((lambda *s: torch.randn(*s, dtype=torch.bfloat16) * 0.05)(Hq * Dh, D) * ((Hq * Dh) ** -0.5)),
        }
    _A_in = _A_setup()

    def _B_setup():
        B, Sq, D = 8, 80, 512
        Hq, Hkv, Sk, Dh = 32, 8, 2048, 128
        assert Hq % Hkv == 0, (Hq, Hkv)
        return {
            "x": _w((lambda *s: torch.randn(*s, dtype=torch.bfloat16) * 0.8)(B, Sq, D)),
            "k_cache": _w((lambda *s: torch.randn(*s, dtype=torch.bfloat16) * 0.8)(B, Hkv, Sk, Dh)),
            "v_cache": _w((lambda *s: torch.randn(*s, dtype=torch.bfloat16) * 0.05)(B, Hkv, Sk, Dh)),
            "wq": _w((lambda *s: torch.randn(*s, dtype=torch.bfloat16) * 0.8)(D, Hq * Dh) * (D ** -0.5)),
            "wo": _w((lambda *s: torch.randn(*s, dtype=torch.bfloat16) * 0.05)(Hq * Dh, D) * ((Hq * Dh) ** -0.5)),
        }
    _B_in = _B_setup()

    return {
        "A_x": _A_in["x"],
        "A_k_cache": _A_in["k_cache"],
        "A_v_cache": _A_in["v_cache"],
        "A_wq": _A_in["wq"],
        "A_wo": _A_in["wo"],
        "B_x": _B_in["x"],
        "B_k_cache": _B_in["k_cache"],
        "B_v_cache": _B_in["v_cache"],
        "B_wq": _B_in["wq"],
        "B_wo": _B_in["wo"],
    }

def reference(A_x, A_k_cache, A_v_cache, A_wq, A_wo, B_x, B_k_cache, B_v_cache, B_wq, B_wo):
    def _A_ref(x, k_cache, v_cache, wq, wo):
        B, Sq, D = x.shape
        Hq, Dh = 32, 128
        Hkv = k_cache.shape[1]
        rep = Hq // Hkv
        q = (lambda x, *d: x.permute(*d))((x @ wq).reshape(B, Sq, Hq, Dh), 0, 2, 1, 3)
        k = (lambda x, n, axis: torch.repeat_interleave(x, n, dim=axis))(k_cache, rep, axis=1)
        v = (lambda x, n, axis: torch.repeat_interleave(x, n, dim=axis))(v_cache, rep, axis=1)
        scores = torch.einsum("bhqd,bhkd->bhqk", q, k) * (Dh ** -0.5)
        p = _softmax(scores, axis=-1)
        o = torch.einsum("bhqk,bhkd->bhqd", p, v)
        return (lambda x, *d: x.permute(*d))(o, 0, 2, 1, 3).reshape(B, Sq, Hq * Dh) @ wo

    def _B_ref(x, k_cache, v_cache, wq, wo):
        B, Sq, D = x.shape
        Hq, Dh = 32, 128
        Hkv = k_cache.shape[1]
        rep = Hq // Hkv
        q = (lambda x, *d: x.permute(*d))((x @ wq).reshape(B, Sq, Hq, Dh), 0, 2, 1, 3)
        k = (lambda x, n, axis: torch.repeat_interleave(x, n, dim=axis))(k_cache, rep, axis=1)
        v = (lambda x, n, axis: torch.repeat_interleave(x, n, dim=axis))(v_cache, rep, axis=1)
        scores = torch.einsum("bhqd,bhkd->bhqk", q, k) * (Dh ** -0.5)
        p = _softmax(scores, axis=-1)
        o = torch.einsum("bhqk,bhkd->bhqd", p, v)
        return (lambda x, *d: x.permute(*d))(o, 0, 2, 1, 3).reshape(B, Sq, Hq * Dh) @ wo

    a = _A_ref(A_x, A_k_cache, A_v_cache, A_wq, A_wo)
    b = _B_ref(B_x, B_k_cache, B_v_cache, B_wq, B_wo)
    return torch.concatenate([a, b], axis=-1)
```

```asm
; @launch grid=(256,1,1) block=(256,1,1) lds=163840
.amdgcn_target "amdgcn-amd-amdhsa--gfx950"
.text
.globl concat_heads__gqa_block_cached__gqa_block_cached__near_ridge_kernel
.p2align 8
.type concat_heads__gqa_block_cached__gqa_block_cached__near_ridge_kernel,@function
concat_heads__gqa_block_cached__gqa_block_cached__near_ridge_kernel:
    s_cmp_ge_u32 s2, 0x100
    s_cbranch_scc1 L_end
    s_load_dwordx16 s[48:63], s[0:1], 0
    s_load_dwordx4 s[64:67], s[0:1], 64
    s_load_dwordx4 s[76:79], s[0:1], 88
    s_load_dwordx2 s[68:69], s[0:1], 80
    s_lshr_b32 s45, s2, 3
    s_getpc_b64 s[74:75]
L_pc:
    s_lshl_b32 s46, s45, 10
    v_lshrrev_b32 v21, 5, v0
    s_min_u32 s46, s46, L_code_end-L_pc-1024
    v_lshlrev_b32 v21, 7, v21
    s_add_u32 s74, s74, s46
    s_addc_u32 s75, s75, 0
    global_load_dword v242, v21, s[74:75]
    v_lshrrev_b32 v247, 6, v0
    v_bfe_u32 v250, v0, 3, 3
    v_readfirstlane_b32 s32, v247
    v_and_b32 v252, 7, v0
    v_and_b32 v22, 6, v250
    v_xor_b32 v251, v252, v22
    v_and_b32 v22, 4, v250
    v_add_u32 v22, v22, v250
    v_lshlrev_b32 v22, 13, v22
    v_lshl_add_u32 v22, v247, 7, v22
    v_lshl_add_u32 v232, v251, 4, v22
    v_add_u32 v233, 130016, v232
    v_add_u32 v234, 30656, v232
    v_add_u32 v235, 160672, v232
    s_and_b32 s44, s2, 3
    s_lshl_b32 s44, s44, 2
    s_and_b32 s46, s45, 3
    s_add_u32 s44, s44, s46
    s_lshr_b32 s33, s45, 2
    s_mul_i32 s81, s33, 4
    s_mul_i32 s46, s46, 4
    s_add_u32 s81, s81, s46
    s_and_b32 s81, s81, 15
    s_and_b32 s46, s32, 2
    s_add_u32 s3, s81, s46
    s_lshl_b32 s3, s3, 6
    s_lshl_b32 s81, s81, 18
    s_mul_i32 s46, s46, 0x840
    s_and_b32 s45, s32, 1
    s_mul_i32 s45, s45, 0x2100
    s_add_u32 s40, s45, s46
    s_lshl_b32 s45, s44, 9
    s_sub_u32 s18, 0x400000, s45
    s_mov_b32 s19, 0x20000
    s_add_u32 m0, s40, 0x10800
    v_bfe_u32 v23, v0, 3, 4
    v_lshrrev_b32 v22, 1, v23
    v_xor_b32 v22, v22, v252
    v_lshlrev_b32 v22, 4, v22
    v_lshl_add_u32 v236, v23, 10, v22
    s_mul_i32 s46, s33, 0x14000
    s_bitcmp0_b32 s2, 2
    s_waitcnt lgkmcnt(0)
    s_cselect_b64 s[16:17], s[54:55], s[64:65]
    s_cselect_b64 s[4:5], s[48:49], s[58:59]
    s_cselect_b64 s[70:71], s[50:51], s[60:61]
    s_cselect_b64 s[72:73], s[52:53], s[62:63]
    s_cselect_b64 s[20:21], s[56:57], s[66:67]
    s_add_u32 s16, s16, s45
    s_addc_u32 s17, s17, 0
    s_and_b32 s17, s17, 0xffff
    buffer_load_dwordx4 v232, s[16:19], s81 offen lds
    buffer_load_dwordx4 v233, s[16:19], s81 offen offset:1056 lds
    buffer_load_dwordx4 v234, s[16:19], s81 offen offset:2112 lds
    buffer_load_dwordx4 v235, s[16:19], s81 offen offset:3168 lds
    s_add_u32 s4, s4, s46
    s_addc_u32 s5, s5, 0
    s_and_b32 s5, s5, 0xffff
    s_mov_b32 s6, 0x14000
    s_mov_b32 s7, 0x20000
    s_lshl_b32 s47, s32, 10
    s_and_b32 s48, s3, 0x3ff
    s_add_u32 m0, s47, 0xb800
    v_add_u32 v216, 16384, v236
    buffer_load_dwordx4 v236, s[4:7], s48 offen lds
    s_add_u32 m0, s47, 0xc800
    v_add_u32 v217, 32768, v236
    buffer_load_dwordx4 v216, s[4:7], s48 offen lds
    s_add_u32 m0, s47, 0xd800
    v_add_u32 v218, 49152, v236
    buffer_load_dwordx4 v217, s[4:7], s48 offen lds
    s_add_u32 m0, s47, 0xe800
    v_add_u32 v219, 65536, v236
    buffer_load_dwordx4 v218, s[4:7], s48 offen lds
    s_add_u32 m0, s47, 0xf800
    s_nop 0
    buffer_load_dwordx4 v219, s[4:7], s48 offen lds
    s_add_u32 m0, s40, 0x14a00
    s_add_u32 s81, s81, 0x40000
    s_and_b32 s81, s81, 0x3fffff
    buffer_load_dwordx4 v232, s[16:19], s81 offen lds
    buffer_load_dwordx4 v233, s[16:19], s81 offen offset:1056 lds
    buffer_load_dwordx4 v234, s[16:19], s81 offen offset:2112 lds
    s_bfe_u32 s36, s2, 0x10002
    v_and_b32 v244, 63, v0
    s_lshl_b32 s45, s36, 3
    s_add_u32 s57, s45, s33
    v_lshlrev_b32 v1, 4, v244
    s_mul_i32 s45, s57, 0x148000
    s_add_u32 s24, s78, s45
    s_addc_u32 s25, s79, 0
    s_and_b32 s25, s25, 0xffff
    s_mov_b32 s26, 0x148000
    s_mov_b32 s27, 0x20000
    s_lshl_b32 s45, s44, 3
    s_add_u32 s45, s45, s32
    s_mul_i32 s54, s45, 0x2800
    v_bfe_u32 v68, v1, 5, 3
    v_lshrrev_b32 v69, 9, v1
    v_sub_u32 v69, v68, v69
    v_min_u32 v69, 4, v69
    v_lshlrev_b32 v69, v69, 1
    v_bfe_i32 v68, 31, v68, 1
    v_and_b32 v69, v68, v69
    v_bfe_i32 v68, v69, 0, 1
    v_and_b32 v68, 1065369472, v68
    v_accvgpr_write_b32 a224, v68
    v_accvgpr_write_b32 a225, v68
    v_accvgpr_write_b32 a226, v68
    v_accvgpr_write_b32 a227, v68
    v_bfe_i32 v68, v69, 2, 1
    v_and_b32 v68, 1065369472, v68
    v_accvgpr_write_b32 a228, v68
    v_accvgpr_write_b32 a229, v68
    v_accvgpr_write_b32 a230, v68
    v_accvgpr_write_b32 a231, v68
    v_bfe_i32 v68, v69, 4, 1
    v_and_b32 v68, 1065369472, v68
    v_accvgpr_write_b32 a232, v68
    v_accvgpr_write_b32 a233, v68
    v_accvgpr_write_b32 a234, v68
    v_accvgpr_write_b32 a235, v68
    v_bfe_i32 v68, v69, 1, 1
    v_and_b32 v68, 1065369472, v68
    v_accvgpr_write_b32 a236, v68
    v_accvgpr_write_b32 a237, v68
    v_accvgpr_write_b32 a238, v68
    v_accvgpr_write_b32 a239, v68
    v_bfe_i32 v68, v69, 3, 1
    v_and_b32 v68, 1065369472, v68
    v_accvgpr_write_b32 a248, v68
    v_accvgpr_write_b32 a249, v68
    v_accvgpr_write_b32 a250, v68
    v_accvgpr_write_b32 a251, v68
    v_mov_b32 v72, 0
    v_mov_b32 v73, 0
    v_mov_b32 v74, 0
    v_mov_b32 v75, 0
    v_mov_b32 v76, 0
    v_mov_b32 v77, 0
    v_mov_b32 v78, 0
    v_mov_b32 v79, 0
    v_mov_b32 v80, 0
    v_mov_b32 v81, 0
    v_mov_b32 v82, 0
    v_mov_b32 v83, 0
    v_mov_b32 v84, 0
    v_mov_b32 v85, 0
    v_mov_b32 v86, 0
    v_mov_b32 v87, 0
    v_mov_b32 v88, 0
    v_mov_b32 v89, 0
    v_mov_b32 v90, 0
    v_mov_b32 v91, 0
    v_mov_b32 v92, 0
    v_mov_b32 v93, 0
    v_mov_b32 v94, 0
    v_mov_b32 v95, 0
    v_mov_b32 v96, 0
    v_mov_b32 v97, 0
    v_mov_b32 v98, 0
    v_mov_b32 v99, 0
    v_mov_b32 v100, 0
    v_mov_b32 v101, 0
    v_mov_b32 v102, 0
    v_mov_b32 v103, 0
    s_add_u32 s49, s3, 0x100
    s_and_b32 s49, s49, 0x3ff
    s_add_u32 s50, s3, 0x200
    s_and_b32 s50, s50, 0x3ff
    s_add_u32 s51, s3, 0x300
    s_and_b32 s51, s51, 0x3ff
    s_and_b32 s35, s44, 1
    s_lshr_b32 s34, s44, 1
    v_and_b32 v248, 1, v247
    v_lshrrev_b32 v249, 1, v247
    v_and_b32 v22, 4, v250
    v_mad_u32_u24 v22, v22, 3, v250
    v_lshlrev_b32 v22, 10, v22
    v_lshl_add_u32 v22, v247, 7, v22
    v_lshl_add_u32 v228, v251, 4, v22
    v_add_u32 v229, 3040, v228
    v_add_u32 v230, 6080, v228
    v_add_u32 v231, 9120, v228
    s_lshl_b32 s45, s33, 3
    s_add_u32 s45, s45, s34
    s_lshl_b32 s45, s45, 19
    s_add_u32 s28, s70, s45
    s_addc_u32 s29, s71, 0
    s_sub_u32 s28, s28, 0x60
    s_subb_u32 s29, s29, 0
    s_and_b32 s29, s29, 0xffff
    s_add_u32 s30, s72, s45
    s_addc_u32 s31, s73, 0
    s_sub_u32 s30, s30, 0x60
    s_subb_u32 s31, s31, 0
    s_and_b32 s31, s31, 0xffff
    s_load_dword s60, s[28:29], 96
    s_load_dword s64, s[30:31], 96
    s_mov_b32 s8, s28
    s_mov_b32 s9, s29
    s_mov_b32 s12, s30
    s_mov_b32 s13, s31
    s_mov_b32 s42, 0x80060
    s_mov_b32 s10, s42
    s_mov_b32 s14, s42
    s_mov_b32 s39, 0x4000
    s_mov_b32 s38, 0x10000
    s_mov_b32 s37, 0
    s_mov_b32 s43, 0
    s_mov_b64 vcc, 0
    s_mov_b32 s11, 0x20000
    s_mov_b32 s15, 0x20000
    s_lshl_b32 s45, s34, 19
    s_lshl_b32 s46, s35, 9
    s_add_u32 s45, s45, s46
    s_sub_u32 s46, 0x80000, s46
    s_add_u32 s20, s20, s45
    s_addc_u32 s21, s21, 0
    s_and_b32 s21, s21, 0xffff
    s_mov_b32 s22, s46
    s_mov_b32 s23, 0x20000
    s_mov_b32 s70, s57
    s_mov_b32 s71, s44
    s_mov_b32 s41, 0
    s_mov_b32 s45, 0x1ce00
    s_mov_b32 s46, 0x1800
    v_lshrrev_b32 v245, 4, v244
    v_and_b32 v246, 15, v244
    v_bfe_u32 v251, v244, 2, 2
    v_and_b32 v252, 3, v244
    v_lshrrev_b32 v21, 1, v246
    v_xor_b32 v21, v21, v245
    v_lshlrev_b32 v21, 4, v21
    v_lshl_add_u32 v237, v246, 7, v21
    v_xor_b32 v238, 64, v237
    v_add_u32 v239, 135168, v237
    v_add_u32 v240, 135168, v238
    v_accvgpr_write_b32 a240, v228
    v_accvgpr_write_b32 a241, v229
    v_accvgpr_write_b32 a242, v230
    v_accvgpr_write_b32 a243, v231
    v_lshrrev_b32 v253, 2, v1
    v_lshrrev_b32 v254, 8, v1
    s_lshl_b32 s74, s32, 8
    s_add_u32 s74, s74, 0x27000
    v_add_u32 v255, s74, v253
    v_lshl_add_u32 v254, v254, 4, s74
    s_mov_b32 s74, 0x3e0293ee
    s_mov_b32 s75, s74
    buffer_load_dwordx4 v235, s[16:19], s81 offen offset:3168 lds
    v_add_u32 v237, 6144, v237
    v_add_u32 v238, 6144, v238
    v_mul_u32_u24 v21, 4224, v249
    v_mul_u32_u24 v22, 8448, v248
    v_add_u32 v23, v21, v1
    v_add_u32 v19, v23, v22
    v_sub_u32 v20, v23, v22
    v_add_u32 v20, 8448, v20
    s_add_u32 m0, s40, 0x18c00
    s_add_u32 s81, s81, 0x40000
    s_and_b32 s81, s81, 0x3fffff
    buffer_load_dwordx4 v232, s[16:19], s81 offen lds
    v_add_u32 v23, v21, v22
    v_and_b32 v21, 1, v245
    v_lshl_add_u32 v21, v21, 2, v251
    v_lshl_add_u32 v23, v21, 7, v23
    v_lshl_add_u32 v23, v252, 3, v23
    v_lshrrev_b32 v15, 1, v245
    v_mul_u32_u24 v15, 1056, v15
    v_add_u32 v23, v23, v15
    buffer_load_dwordx4 v233, s[16:19], s81 offen offset:1056 lds
    v_add_u32 v23, 67584, v23
    v_and_b32 v21, 6, v21
    v_xor_b32 v12, 0, v21
    v_lshl_add_u32 v222, v12, 4, v23
    v_subrev_u32 v12, 67584, v222
    v_xor_b32 v13, 2, v21
    v_lshl_add_u32 v223, v13, 4, v23
    v_subrev_u32 v13, 67584, v223
    buffer_load_dwordx4 v234, s[16:19], s81 offen offset:2112 lds
    v_xor_b32 v14, 4, v21
    v_lshl_add_u32 v224, v14, 4, v23
    v_subrev_u32 v14, 67584, v224
    v_xor_b32 v15, 6, v21
    v_lshl_add_u32 v225, v15, 4, v23
    v_subrev_u32 v15, 67584, v225
    v_and_b32 v21, 7, v246
    v_mul_u32_u24 v21, 1056, v21
    buffer_load_dwordx4 v235, s[16:19], s81 offen offset:3168 lds
    v_lshrrev_b32 v23, 3, v246
    v_lshl_add_u32 v21, v23, 8, v21
    v_lshl_add_u32 v21, v245, 4, v21
    v_add_u32 v6, v21, v22
    v_add_u32 v7, 67584, v6
    v_bfe_u32 v21, v244, 2, 3
    v_mul_u32_u24 v21, 1056, v21
    v_lshrrev_b32 v23, 1, v245
    s_add_u32 m0, s40, 0x1ce00
    s_add_u32 s81, s81, 0x40000
    s_and_b32 s81, s81, 0x3fffff
    buffer_load_dwordx4 v232, s[16:19], s81 offen lds
    v_lshl_add_u32 v21, v23, 8, v21
    v_lshl_add_u32 v21, v252, 3, v21
    v_add_u32 v21, v21, v22
    v_lshl_add_u32 v8, v248, 7, v21
    v_xor_b32 v23, 1, v248
    v_lshl_add_u32 v10, v23, 7, v21
    v_add_u32 v9, 67584, v8
    v_add_u32 v11, 67584, v10
    buffer_load_dwordx4 v233, s[16:19], s81 offen offset:1056 lds
    v_lshl_add_u32 v21, v248, 13, v1
    v_lshl_add_u32 v21, v249, 12, v21
    v_add_u32 v2, 96, v21
    v_add_u32 v3, 64, v21
    v_add_u32 v4, 32, v21
    v_add_u32 v5, 0, v21
    v_lshrrev_b32 v21, 1, v245
    v_lshl_add_u32 v21, v21, 4, v246
    buffer_load_dwordx4 v234, s[16:19], s81 offen offset:2112 lds
    v_lshlrev_b32 v21, 4, v21
    v_and_b32 v23, 1, v245
    v_lshl_add_u32 v21, v23, 3, v21
    v_sub_u32 v23, v19, v1
    v_mad_u32_u24 v17, v247, s46, v21
    v_add3_u32 v21, v21, v23, s45
    v_add_u32 v17, 135168, v17
    v_mul_u32_u24 v22, 4224, v249
    buffer_load_dwordx4 v235, s[16:19], s81 offen offset:3168 lds
    v_mul_u32_u24 v23, 12288, v249
    v_add3_u32 v22, v22, v1, s45
    v_add_u32 v23, v23, v1
    v_add_u32 v23, 135168, v23
    v_accvgpr_write_b32 a244, v2
    v_accvgpr_write_b32 a245, v3
    v_accvgpr_write_b32 a246, v4
    v_accvgpr_write_b32 a247, v5
    s_lshl_b32 s65, s35, 2
    s_add_u32 s65, s65, s32
    s_mul_i32 s65, s65, 0x1000
    s_lshl_b32 s45, s34, 1
    s_add_u32 s65, s65, s45
    s_add_u32 s65, s65, 0x140000
    s_mul_i32 s66, s71, 0x800
    s_lshl_b32 s45, s32, 8
    s_add_u32 s66, s66, s45
    s_add_u32 s66, s66, 0x140400
    v_lshrrev_b32 v246, 5, v1
    v_mul_u32_u24 v245, 128, v1
    v_lshl_add_u32 v245, v246, 24, v245
    v_lshlrev_b32 v247, 20, v1
    v_mov_b32 v244, 0
    buffer_store_short v244, v245, s[24:27], s65 offen sc1
    buffer_store_dword v244, v247, s[24:27], s66 offen sc1
    s_buffer_load_dword s61, s[24:27], s66 offset:128
    s_lshl_b32 s45, s71, 3
    s_add_u32 s45, s45, s32
    s_mul_i32 s45, s45, 0x2800
    v_add_u32 v0, s45, v1
    v_mov_b32 v244, v222
    v_mov_b32 v245, v223
    v_mov_b32 v246, v224
    v_mov_b32 v247, v225
    v_add_u32 v248, 135168, v19
    v_add_u32 v249, 135168, v20
    v_add_u32 v19, 67584, v19
    v_add_u32 v20, 67584, v20
    s_lshl_b32 s45, s32, 11
    s_add_u32 s45, s45, 0x25200
    s_xor_b32 s46, s45, 0x800
    v_add_u32 v250, s45, v1
    v_add_u32 v251, s46, v1
    v_bfe_u32 v252, v1, 4, 4
    v_lshrrev_b32 v228, 8, v1
    v_lshl_add_u32 v252, v252, 2, s46
    v_lshl_add_u32 v252, v228, 7, v252
    v_lshlrev_b32 v229, 6, v228
    v_lshl_add_u32 v228, v228, 4, s46
    v_xor_b32 v230, v229, v1
    v_xor_b32 v229, v229, v0
    v_sub_u32 v230, v230, v1
    v_add_u32 v230, v230, v20
    v_bfe_u32 v70, v1, 4, 2
    v_lshrrev_b32 v71, 9, v1
    v_xor_b32 v71, v71, v70
    v_lshlrev_b32 v70, 8, v70
    v_lshl_add_u32 v70, v71, 6, v70
    v_bfe_u32 v71, v1, 6, 2
    v_lshl_add_u32 v70, v71, 4, v70
    v_bfe_u32 v71, v1, 8, 1
    v_lshl_add_u32 v70, v71, 3, v70
    v_xor_b32 v71, 128, v70
    v_add_u32 v70, 67584, v70
    v_add_u32 v71, 67584, v71
    s_lshl_b32 s45, s32, 2
    s_add_u32 s45, s45, 0x27200
    v_accvgpr_write_b32 a252, v70
    v_accvgpr_write_b32 a253, v71
    v_mov_b32 v70, s45
    v_accvgpr_write_b32 a254, v70
    s_waitcnt vmcnt(14)
    s_barrier
    ds_read_b64_tr_b16 v[184:185], v222
    ds_read_b64_tr_b16 v[186:187], v222 offset:2112
    ds_read_b64_tr_b16 v[188:189], v223
    ds_read_b64_tr_b16 v[190:191], v223 offset:2112
    ds_read_b64_tr_b16 v[192:193], v224
    ds_read_b64_tr_b16 v[194:195], v224 offset:2112
    ds_read_b64_tr_b16 v[196:197], v225
    ds_read_b64_tr_b16 v[198:199], v225 offset:2112
    ds_read_b128 a[160:163], v237 offset:40960
    ds_read_b128 a[164:167], v237 offset:45056
    ds_read_b128 a[168:171], v237 offset:49152
    ds_read_b128 a[172:175], v237 offset:53248
    ds_read_b128 a[176:179], v237 offset:57344
    s_add_u32 m0, s47, 0x6800
    s_nop 0
    buffer_load_dwordx4 v236, s[4:7], s49 offen lds
    ds_read_b128 a[180:183], v238 offset:40960
    s_add_u32 m0, s47, 0x7800
    s_nop 0
    buffer_load_dwordx4 v216, s[4:7], s49 offen lds
    ds_read_b128 a[184:187], v238 offset:45056
    s_add_u32 m0, s47, 0x8800
    s_nop 0
    buffer_load_dwordx4 v217, s[4:7], s49 offen lds
    ds_read_b128 a[188:191], v238 offset:49152
    s_add_u32 m0, s47, 0x9800
    s_nop 0
    buffer_load_dwordx4 v218, s[4:7], s49 offen lds
    ds_read_b128 a[192:195], v238 offset:53248
    s_add_u32 m0, s47, 0xa800
    s_nop 0
    buffer_load_dwordx4 v219, s[4:7], s49 offen lds
    ds_read_b128 a[196:199], v238 offset:57344
    s_waitcnt lgkmcnt(5)
    v_mfma_f32_16x16x32_bf16 v[168:171], v[184:187], a[160:163], 0
    s_waitcnt vmcnt(17)
    ds_read_b64_tr_b16 v[200:201], v222 offset:16896
    v_mfma_f32_16x16x32_bf16 v[172:175], v[188:191], a[160:163], 0
    ds_read_b64_tr_b16 v[204:205], v223 offset:16896
    ds_read_b64_tr_b16 v[208:209], v224 offset:16896
    v_mfma_f32_16x16x32_bf16 v[176:179], v[192:195], a[160:163], 0
    ds_read_b64_tr_b16 v[212:213], v225 offset:16896
    s_waitcnt vmcnt(15)
    v_mfma_f32_16x16x32_bf16 v[180:183], v[196:199], a[160:163], 0
    ds_read_b64_tr_b16 v[202:203], v222 offset:19008
    ds_read_b64_tr_b16 v[206:207], v223 offset:19008
    v_mfma_f32_16x16x32_bf16 v[104:107], v[184:187], a[164:167], 0
    ds_read_b64_tr_b16 v[210:211], v224 offset:19008
    ds_read_b64_tr_b16 v[214:215], v225 offset:19008
    v_mfma_f32_16x16x32_bf16 v[108:111], v[188:191], a[164:167], 0
    s_add_u32 m0, s40, 0x10800
    s_add_u32 s81, s81, 0x40000
    s_and_b32 s81, s81, 0x3fffff
    v_mfma_f32_16x16x32_bf16 v[112:115], v[192:195], a[164:167], 0
    buffer_load_dwordx4 v232, s[16:19], s81 offen lds
    v_mfma_f32_16x16x32_bf16 v[116:119], v[196:199], a[164:167], 0
    ds_read_b128 a[200:203], v237 offset:43008
    v_mfma_f32_16x16x32_bf16 v[120:123], v[184:187], a[168:171], 0
    buffer_load_dwordx4 v233, s[16:19], s81 offen offset:1056 lds
    v_mfma_f32_16x16x32_bf16 v[124:127], v[188:191], a[168:171], 0
    ds_read_b128 a[204:207], v237 offset:47104
    v_mfma_f32_16x16x32_bf16 v[128:131], v[192:195], a[168:171], 0
    buffer_load_dwordx4 v234, s[16:19], s81 offen offset:2112 lds
    v_mfma_f32_16x16x32_bf16 v[132:135], v[196:199], a[168:171], 0
    ds_read_b128 a[208:211], v237 offset:51200
    v_mfma_f32_16x16x32_bf16 v[136:139], v[184:187], a[172:175], 0
    buffer_load_dwordx4 v235, s[16:19], s81 offen offset:3168 lds
    v_mfma_f32_16x16x32_bf16 v[140:143], v[188:191], a[172:175], 0
    ds_read_b128 a[212:215], v237 offset:55296
    s_add_u32 m0, s47, 0x1800
    v_mfma_f32_16x16x32_bf16 v[144:147], v[192:195], a[172:175], 0
    buffer_load_dwordx4 v236, s[4:7], s50 offen lds
    v_mfma_f32_16x16x32_bf16 v[148:151], v[196:199], a[172:175], 0
    ds_read_b128 a[216:219], v237 offset:59392
    s_add_u32 m0, s47, 0x2800
    v_mfma_f32_16x16x32_bf16 v[152:155], v[184:187], a[176:179], 0
    buffer_load_dwordx4 v216, s[4:7], s50 offen lds
    s_add_u32 m0, s47, 0x3800
    v_mfma_f32_16x16x32_bf16 v[156:159], v[188:191], a[176:179], 0
    buffer_load_dwordx4 v217, s[4:7], s50 offen lds
    s_add_u32 m0, s47, 0x4800
    v_mfma_f32_16x16x32_bf16 v[160:163], v[192:195], a[176:179], 0
    buffer_load_dwordx4 v218, s[4:7], s50 offen lds
    s_add_u32 m0, s47, 0x5800
    v_mfma_f32_16x16x32_bf16 v[164:167], v[196:199], a[176:179], 0
    buffer_load_dwordx4 v219, s[4:7], s50 offen lds
    s_waitcnt lgkmcnt(5)
    v_mfma_f32_16x16x32_bf16 v[168:171], v[200:203], a[180:183], v[168:171]
    s_waitcnt vmcnt(22)
    ds_read_b64_tr_b16 v[24:25], v222 offset:33792
    v_mfma_f32_16x16x32_bf16 v[172:175], v[204:207], a[180:183], v[172:175]
    ds_read_b64_tr_b16 v[28:29], v223 offset:33792
    ds_read_b64_tr_b16 v[32:33], v224 offset:33792
    v_mfma_f32_16x16x32_bf16 v[176:179], v[208:211], a[180:183], v[176:179]
    ds_read_b64_tr_b16 v[36:37], v225 offset:33792
    s_waitcnt vmcnt(20)
    v_mfma_f32_16x16x32_bf16 v[180:183], v[212:215], a[180:183], v[180:183]
    ds_read_b64_tr_b16 v[26:27], v222 offset:35904
    ds_read_b64_tr_b16 v[30:31], v223 offset:35904
    v_mfma_f32_16x16x32_bf16 v[104:107], v[200:203], a[184:187], v[104:107]
    ds_read_b64_tr_b16 v[34:35], v224 offset:35904
    ds_read_b64_tr_b16 v[38:39], v225 offset:35904
    v_mfma_f32_16x16x32_bf16 v[108:111], v[204:207], a[184:187], v[108:111]
    s_add_u32 m0, s40, 0x14a00
    s_add_u32 s81, s81, 0x40000
    s_and_b32 s81, s81, 0x3fffff
    v_mfma_f32_16x16x32_bf16 v[112:115], v[208:211], a[184:187], v[112:115]
    buffer_load_dwordx4 v232, s[16:19], s81 offen lds
    v_mfma_f32_16x16x32_bf16 v[116:119], v[212:215], a[184:187], v[116:119]
    ds_read_b128 a[220:223], v238 offset:43008
    v_mfma_f32_16x16x32_bf16 v[120:123], v[200:203], a[188:191], v[120:123]
    buffer_load_dwordx4 v233, s[16:19], s81 offen offset:1056 lds
    v_mfma_f32_16x16x32_bf16 v[124:127], v[204:207], a[188:191], v[124:127]
    ds_read_b128 a[0:3], v238 offset:47104
    v_mfma_f32_16x16x32_bf16 v[128:131], v[208:211], a[188:191], v[128:131]
    buffer_load_dwordx4 v234, s[16:19], s81 offen offset:2112 lds
    v_mfma_f32_16x16x32_bf16 v[132:135], v[212:215], a[188:191], v[132:135]
    ds_read_b128 a[4:7], v238 offset:51200
    v_mfma_f32_16x16x32_bf16 v[136:139], v[200:203], a[192:195], v[136:139]
    buffer_load_dwordx4 v235, s[16:19], s81 offen offset:3168 lds
    v_mfma_f32_16x16x32_bf16 v[140:143], v[204:207], a[192:195], v[140:143]
    ds_read_b128 a[8:11], v238 offset:55296
    s_add_u32 m0, s47, 0x21000
    v_mfma_f32_16x16x32_bf16 v[144:147], v[208:211], a[192:195], v[144:147]
    buffer_load_dwordx4 v236, s[4:7], s51 offen lds
    v_mfma_f32_16x16x32_bf16 v[148:151], v[212:215], a[192:195], v[148:151]
    ds_read_b128 a[12:15], v238 offset:59392
    s_add_u32 m0, s47, 0x22000
    v_mfma_f32_16x16x32_bf16 v[152:155], v[200:203], a[196:199], v[152:155]
    buffer_load_dwordx4 v216, s[4:7], s51 offen lds
    s_add_u32 m0, s47, 0x23000
    v_mfma_f32_16x16x32_bf16 v[156:159], v[204:207], a[196:199], v[156:159]
    buffer_load_dwordx4 v217, s[4:7], s51 offen lds
    s_add_u32 m0, s47, 0x24000
    v_mfma_f32_16x16x32_bf16 v[160:163], v[208:211], a[196:199], v[160:163]
    buffer_load_dwordx4 v218, s[4:7], s51 offen lds
    s_add_u32 m0, s47, 0x25000
    v_mfma_f32_16x16x32_bf16 v[164:167], v[212:215], a[196:199], v[164:167]
    buffer_load_dwordx4 v219, s[4:7], s51 offen lds
    s_waitcnt vmcnt(18) lgkmcnt(0)
    s_barrier
    v_mfma_f32_16x16x32_bf16 v[168:171], v[24:27], a[200:203], v[168:171]
    s_add_u32 m0, s40, 0x18c00
    s_add_u32 s81, s81, 0x40000
    s_and_b32 s81, s81, 0x3fffff
    v_mfma_f32_16x16x32_bf16 v[172:175], v[28:31], a[200:203], v[172:175]
    buffer_load_dwordx4 v232, s[16:19], s81 offen lds
    v_mfma_f32_16x16x32_bf16 v[176:179], v[32:35], a[200:203], v[176:179]
    ds_read_b128 a[16:19], v237 offset:20480
    v_mfma_f32_16x16x32_bf16 v[180:183], v[36:39], a[200:203], v[180:183]
    ds_read_b128 a[20:23], v237 offset:24576
    v_mfma_f32_16x16x32_bf16 v[104:107], v[24:27], a[204:207], v[104:107]
    ds_read_b128 a[24:27], v237 offset:28672
    v_mfma_f32_16x16x32_bf16 v[108:111], v[28:31], a[204:207], v[108:111]
    buffer_load_dwordx4 v233, s[16:19], s81 offen offset:1056 lds
    s_waitcnt vmcnt(29)
    v_mfma_f32_16x16x32_bf16 v[112:115], v[32:35], a[204:207], v[112:115]
    ds_read_b64_tr_b16 v[184:185], v222 offset:50688
    ds_read_b64_tr_b16 v[188:189], v223 offset:50688
    v_mfma_f32_16x16x32_bf16 v[116:119], v[36:39], a[204:207], v[116:119]
    ds_read_b64_tr_b16 v[192:193], v224 offset:50688
    ds_read_b64_tr_b16 v[196:197], v225 offset:50688
    v_mfma_f32_16x16x32_bf16 v[120:123], v[24:27], a[208:211], v[120:123]
    ds_read_b128 a[28:31], v237 offset:32768
    v_mfma_f32_16x16x32_bf16 v[124:127], v[28:31], a[208:211], v[124:127]
    buffer_load_dwordx4 v234, s[16:19], s81 offen offset:2112 lds
    v_mfma_f32_16x16x32_bf16 v[128:131], v[32:35], a[208:211], v[128:131]
    ds_read_b128 a[32:35], v237 offset:36864
    v_mfma_f32_16x16x32_bf16 v[132:135], v[36:39], a[208:211], v[132:135]
    ds_read_b128 a[36:39], v238 offset:20480
    v_mfma_f32_16x16x32_bf16 v[136:139], v[24:27], a[212:215], v[136:139]
    ds_read_b128 a[40:43], v238 offset:24576
    v_mfma_f32_16x16x32_bf16 v[140:143], v[28:31], a[212:215], v[140:143]
    buffer_load_dwordx4 v235, s[16:19], s81 offen offset:3168 lds
    s_waitcnt vmcnt(29)
    v_mfma_f32_16x16x32_bf16 v[144:147], v[32:35], a[212:215], v[144:147]
    ds_read_b64_tr_b16 v[186:187], v222 offset:52800
    ds_read_b64_tr_b16 v[190:191], v223 offset:52800
    v_mfma_f32_16x16x32_bf16 v[148:151], v[36:39], a[212:215], v[148:151]
    ds_read_b64_tr_b16 v[194:195], v224 offset:52800
    ds_read_b64_tr_b16 v[198:199], v225 offset:52800
    v_mfma_f32_16x16x32_bf16 v[152:155], v[24:27], a[216:219], v[152:155]
    ds_read_b128 a[44:47], v238 offset:28672
    s_add_u32 m0, s40, 0xc600
    v_mfma_f32_16x16x32_bf16 v[156:159], v[28:31], a[216:219], v[156:159]
    s_add_u32 s81, s81, 0x40000
    s_and_b32 s81, s81, 0x3fffff
    v_mfma_f32_16x16x32_bf16 v[160:163], v[32:35], a[216:219], v[160:163]
    buffer_load_dwordx4 v232, s[16:19], s81 offen lds
    v_mfma_f32_16x16x32_bf16 v[164:167], v[36:39], a[216:219], v[164:167]
    s_waitcnt lgkmcnt(1)
    v_mfma_f32_16x16x32_bf16 v[168:171], v[184:187], a[220:223], v[168:171]
    buffer_load_dwordx4 v233, s[16:19], s81 offen offset:1056 lds
    s_mul_i32 s70, s70, 16
    v_mfma_f32_16x16x32_bf16 v[172:175], v[188:191], a[220:223], v[172:175]
    ds_read_b128 a[48:51], v238 offset:32768
    s_add_u32 s70, s70, 0
    v_mfma_f32_16x16x32_bf16 v[176:179], v[192:195], a[220:223], v[176:179]
    ds_read_b128 a[52:55], v238 offset:36864
    s_mov_b32 s4, s76
    v_mfma_f32_16x16x32_bf16 v[180:183], v[196:199], a[220:223], v[180:183]
    ds_read_b128 a[56:59], v237 offset:22528
    s_and_b32 s5, s77, 0xffff
    v_mfma_f32_16x16x32_bf16 v[104:107], v[184:187], a[0:3], v[104:107]
    buffer_load_dwordx4 v234, s[16:19], s81 offen offset:2112 lds
    s_waitcnt vmcnt(23)
    v_mfma_f32_16x16x32_bf16 v[108:111], v[188:191], a[0:3], v[108:111]
    ds_read_b64_tr_b16 v[200:201], v222
    ds_read_b64_tr_b16 v[204:205], v223
    v_mfma_f32_16x16x32_bf16 v[112:115], v[192:195], a[0:3], v[112:115]
    ds_read_b64_tr_b16 v[208:209], v224
    ds_read_b64_tr_b16 v[212:213], v225
    v_mfma_f32_16x16x32_bf16 v[116:119], v[196:199], a[0:3], v[116:119]
    ds_read_b128 a[60:63], v237 offset:26624
    s_add_u32 s6, s70, 8
    v_mfma_f32_16x16x32_bf16 v[120:123], v[184:187], a[4:7], v[120:123]
    buffer_load_dwordx4 v235, s[16:19], s81 offen offset:3168 lds
    s_add_u32 m0, s40, 0x1ce00
    v_mfma_f32_16x16x32_bf16 v[124:127], v[188:191], a[4:7], v[124:127]
    ds_read_b128 a[64:67], v237 offset:30720
    s_add_u32 s81, s81, 0x40000
    v_mfma_f32_16x16x32_bf16 v[128:131], v[192:195], a[4:7], v[128:131]
    ds_read_b128 a[68:71], v237 offset:34816
    s_and_b32 s81, s81, 0x3fffff
    v_mfma_f32_16x16x32_bf16 v[132:135], v[196:199], a[4:7], v[132:135]
    ds_read_b128 a[72:75], v237 offset:38912
    s_mov_b32 s72, 0
    v_mfma_f32_16x16x32_bf16 v[136:139], v[184:187], a[8:11], v[136:139]
    buffer_load_dwordx4 v232, s[16:19], s81 offen lds
    s_waitcnt vmcnt(23)
    v_mfma_f32_16x16x32_bf16 v[140:143], v[188:191], a[8:11], v[140:143]
    ds_read_b64_tr_b16 v[202:203], v222 offset:2112
    ds_read_b64_tr_b16 v[206:207], v223 offset:2112
    v_mfma_f32_16x16x32_bf16 v[144:147], v[192:195], a[8:11], v[144:147]
    ds_read_b64_tr_b16 v[210:211], v224 offset:2112
    ds_read_b64_tr_b16 v[214:215], v225 offset:2112
    v_mfma_f32_16x16x32_bf16 v[148:151], v[196:199], a[8:11], v[148:151]
    buffer_load_dword v18, v253, s[8:11], 0 offen offset:96
    s_mov_b32 s73, 0
    v_mfma_f32_16x16x32_bf16 v[152:155], v[184:187], a[12:15], v[152:155]
    buffer_load_dwordx4 v233, s[16:19], s81 offen offset:1056 lds
    s_lshl_b32 s67, s34, 2
    v_mfma_f32_16x16x32_bf16 v[156:159], v[188:191], a[12:15], v[156:159]
    s_add_u32 s67, s67, 0x40000
    s_mov_b32 s56, s20
    v_mfma_f32_16x16x32_bf16 v[160:163], v[192:195], a[12:15], v[160:163]
    s_mov_b32 s57, s21
    s_mov_b32 s59, 0x20000
    v_mfma_f32_16x16x32_bf16 v[164:167], v[196:199], a[12:15], v[164:167]
    s_mul_i32 s3, s35, 0x1ff
    s_lshl_b32 s45, s33, 6
    s_waitcnt lgkmcnt(0)
    v_mfma_f32_16x16x32_bf16 v[168:171], v[200:203], a[16:19], v[168:171]
    buffer_load_dwordx4 v234, s[16:19], s81 offen offset:2112 lds
    s_add_u32 s3, s3, s45
    v_mfma_f32_16x16x32_bf16 v[172:175], v[204:207], a[16:19], v[172:175]
    ds_read_b128 a[76:79], v238 offset:22528
    s_lshl_b32 s3, s3, 9
    v_mfma_f32_16x16x32_bf16 v[176:179], v[208:211], a[16:19], v[176:179]
    ds_read_b128 a[80:83], v238 offset:26624
    s_add_u32 s45, s3, 0x8000
    v_mfma_f32_16x16x32_bf16 v[180:183], v[212:215], a[16:19], v[180:183]
    buffer_load_dwordx4 v235, s[16:19], s81 offen offset:3168 lds
    s_waitcnt vmcnt(20)
    v_mfma_f32_16x16x32_bf16 v[104:107], v[200:203], a[20:23], v[104:107]
    ds_read_b64_tr_b16 v[24:25], v222 offset:16896
    ds_read_b64_tr_b16 v[28:29], v223 offset:16896
    v_mfma_f32_16x16x32_bf16 v[108:111], v[204:207], a[20:23], v[108:111]
    ds_read_b64_tr_b16 v[32:33], v224 offset:16896
    ds_read_b64_tr_b16 v[36:37], v225 offset:16896
    v_mfma_f32_16x16x32_bf16 v[112:115], v[208:211], a[20:23], v[112:115]
    s_add_u32 m0, s40, 0x10800
    s_add_u32 s81, s81, 0x40000
    s_and_b32 s81, s81, 0x3fffff
    v_mfma_f32_16x16x32_bf16 v[116:119], v[212:215], a[20:23], v[116:119]
    buffer_load_dwordx4 v232, s[16:19], s81 offen lds
    s_min_u32 s58, s45, s22
    v_mfma_f32_16x16x32_bf16 v[120:123], v[200:203], a[24:27], v[120:123]
    ds_read_b128 a[84:87], v238 offset:30720
    s_mul_i32 s45, s32, 0x500
    v_mfma_f32_16x16x32_bf16 v[124:127], v[204:207], a[24:27], v[124:127]
    ds_read_b128 a[88:91], v238 offset:34816
    s_add_u32 s3, s3, s45
    v_mfma_f32_16x16x32_bf16 v[128:131], v[208:211], a[24:27], v[128:131]
    buffer_load_dwordx4 v233, s[16:19], s81 offen offset:1056 lds
    s_waitcnt vmcnt(20)
    v_mfma_f32_16x16x32_bf16 v[132:135], v[212:215], a[24:27], v[132:135]
    ds_read_b64_tr_b16 v[26:27], v222 offset:19008
    ds_read_b64_tr_b16 v[30:31], v223 offset:19008
    v_mfma_f32_16x16x32_bf16 v[136:139], v[200:203], a[28:31], v[136:139]
    ds_read_b64_tr_b16 v[34:35], v224 offset:19008
    ds_read_b64_tr_b16 v[38:39], v225 offset:19008
    v_mfma_f32_16x16x32_bf16 v[140:143], v[204:207], a[28:31], v[140:143]
    buffer_load_dwordx4 v234, s[16:19], s81 offen offset:2112 lds
    v_mfma_f32_16x16x32_bf16 v[144:147], v[208:211], a[28:31], v[144:147]
    ds_read_b128 a[92:95], v238 offset:38912
    v_mfma_f32_16x16x32_bf16 v[148:151], v[212:215], a[28:31], v[148:151]
    buffer_load_dwordx4 v235, s[16:19], s81 offen offset:3168 lds
    v_mfma_f32_16x16x32_bf16 v[152:155], v[200:203], a[32:35], v[152:155]
    v_mfma_f32_16x16x32_bf16 v[156:159], v[204:207], a[32:35], v[156:159]
    v_mfma_f32_16x16x32_bf16 v[160:163], v[208:211], a[32:35], v[160:163]
    v_mfma_f32_16x16x32_bf16 v[164:167], v[212:215], a[32:35], v[164:167]
    s_waitcnt vmcnt(17) lgkmcnt(0)
    s_barrier
    v_mfma_f32_16x16x32_bf16 v[168:171], v[24:27], a[36:39], v[168:171]
    s_add_u32 m0, s40, 0x14a00
    s_add_u32 s81, s81, 0x40000
    s_and_b32 s81, s81, 0x3fffff
    v_mfma_f32_16x16x32_bf16 v[172:175], v[28:31], a[36:39], v[172:175]
    buffer_load_dwordx4 v232, s[16:19], s81 offen lds
    v_mfma_f32_16x16x32_bf16 v[176:179], v[32:35], a[36:39], v[176:179]
    ds_read_b128 a[96:99], v237
    v_mfma_f32_16x16x32_bf16 v[180:183], v[36:39], a[36:39], v[180:183]
    ds_read_b128 a[100:103], v237 offset:4096
    v_mfma_f32_16x16x32_bf16 v[104:107], v[24:27], a[40:43], v[104:107]
    ds_read_b128 a[104:107], v237 offset:8192
    v_mfma_f32_16x16x32_bf16 v[108:111], v[28:31], a[40:43], v[108:111]
    buffer_load_dwordx4 v233, s[16:19], s81 offen offset:1056 lds
    s_waitcnt vmcnt(17)
    v_mfma_f32_16x16x32_bf16 v[112:115], v[32:35], a[40:43], v[112:115]
    ds_read_b64_tr_b16 v[184:185], v222 offset:33792
    ds_read_b64_tr_b16 v[188:189], v223 offset:33792
    v_mfma_f32_16x16x32_bf16 v[116:119], v[36:39], a[40:43], v[116:119]
    ds_read_b64_tr_b16 v[192:193], v224 offset:33792
    ds_read_b64_tr_b16 v[196:197], v225 offset:33792
    v_mfma_f32_16x16x32_bf16 v[120:123], v[24:27], a[44:47], v[120:123]
    ds_read_b128 a[108:111], v237 offset:12288
    v_mfma_f32_16x16x32_bf16 v[124:127], v[28:31], a[44:47], v[124:127]
    buffer_load_dwordx4 v234, s[16:19], s81 offen offset:2112 lds
    v_mfma_f32_16x16x32_bf16 v[128:131], v[32:35], a[44:47], v[128:131]
    ds_read_b128 a[112:115], v237 offset:16384
    v_mfma_f32_16x16x32_bf16 v[132:135], v[36:39], a[44:47], v[132:135]
    ds_read_b128 a[116:119], v238
    v_mfma_f32_16x16x32_bf16 v[136:139], v[24:27], a[48:51], v[136:139]
    ds_read_b128 a[120:123], v238 offset:4096
    v_mfma_f32_16x16x32_bf16 v[140:143], v[28:31], a[48:51], v[140:143]
    buffer_load_dwordx4 v235, s[16:19], s81 offen offset:3168 lds
    s_waitcnt vmcnt(17)
    v_mfma_f32_16x16x32_bf16 v[144:147], v[32:35], a[48:51], v[144:147]
    ds_read_b64_tr_b16 v[186:187], v222 offset:35904
    ds_read_b64_tr_b16 v[190:191], v223 offset:35904
    v_mfma_f32_16x16x32_bf16 v[148:151], v[36:39], a[48:51], v[148:151]
    ds_read_b64_tr_b16 v[194:195], v224 offset:35904
    ds_read_b64_tr_b16 v[198:199], v225 offset:35904
    v_mfma_f32_16x16x32_bf16 v[152:155], v[24:27], a[52:55], v[152:155]
    s_add_u32 m0, s40, 0x8400
    s_add_u32 s81, s81, 0x40000
    s_and_b32 s81, s81, 0x3fffff
    v_mfma_f32_16x16x32_bf16 v[156:159], v[28:31], a[52:55], v[156:159]
    buffer_load_dwordx4 v232, s[16:19], s81 offen lds
    v_mfma_f32_16x16x32_bf16 v[160:163], v[32:35], a[52:55], v[160:163]
    v_mfma_f32_16x16x32_bf16 v[164:167], v[36:39], a[52:55], v[164:167]
    s_waitcnt lgkmcnt(0)
    v_mfma_f32_16x16x32_bf16 v[168:171], v[184:187], a[56:59], v[168:171]
    buffer_load_dwordx4 v233, s[16:19], s81 offen offset:1056 lds
    v_mfma_f32_16x16x32_bf16 v[172:175], v[188:191], a[56:59], v[172:175]
    ds_read_b128 a[124:127], v238 offset:8192
    v_mfma_f32_16x16x32_bf16 v[176:179], v[192:195], a[56:59], v[176:179]
    ds_read_b128 a[128:131], v238 offset:12288
    v_mfma_f32_16x16x32_bf16 v[180:183], v[196:199], a[56:59], v[180:183]
    ds_read_b128 a[132:135], v238 offset:16384
    v_mfma_f32_16x16x32_bf16 v[104:107], v[184:187], a[60:63], v[104:107]
    buffer_load_dwordx4 v234, s[16:19], s81 offen offset:2112 lds
    s_waitcnt vmcnt(18)
    v_mfma_f32_16x16x32_bf16 v[108:111], v[188:191], a[60:63], v[108:111]
    ds_read_b64_tr_b16 v[200:201], v12 offset:50688
    ds_read_b64_tr_b16 v[204:205], v13 offset:50688
    v_mfma_f32_16x16x32_bf16 v[112:115], v[192:195], a[60:63], v[112:115]
    ds_read_b64_tr_b16 v[208:209], v14 offset:50688
    ds_read_b64_tr_b16 v[212:213], v15 offset:50688
    v_mfma_f32_16x16x32_bf16 v[116:119], v[196:199], a[60:63], v[116:119]
    ds_read_b128 a[136:139], v237 offset:2048
    v_mfma_f32_16x16x32_bf16 v[120:123], v[184:187], a[64:67], v[120:123]
    buffer_load_dwordx4 v235, s[16:19], s81 offen offset:3168 lds
    s_add_u32 m0, s40, 0x18c00
    v_mfma_f32_16x16x32_bf16 v[124:127], v[188:191], a[64:67], v[124:127]
    ds_read_b128 a[140:143], v237 offset:6144
    s_add_u32 s81, s81, 0x40000
    v_mfma_f32_16x16x32_bf16 v[128:131], v[192:195], a[64:67], v[128:131]
    ds_read_b128 a[144:147], v237 offset:10240
    s_and_b32 s81, s81, 0x3fffff
    v_mfma_f32_16x16x32_bf16 v[132:135], v[196:199], a[64:67], v[132:135]
    ds_read_b128 a[148:151], v237 offset:14336
    v_mfma_f32_16x16x32_bf16 v[136:139], v[184:187], a[68:71], v[136:139]
    buffer_load_dwordx4 v232, s[16:19], s81 offen lds
    s_waitcnt vmcnt(18)
    v_mfma_f32_16x16x32_bf16 v[140:143], v[188:191], a[68:71], v[140:143]
    ds_read_b64_tr_b16 v[202:203], v12 offset:52800
    ds_read_b64_tr_b16 v[206:207], v13 offset:52800
    v_mfma_f32_16x16x32_bf16 v[144:147], v[192:195], a[68:71], v[144:147]
    ds_read_b64_tr_b16 v[210:211], v14 offset:52800
    ds_read_b64_tr_b16 v[214:215], v15 offset:52800
    v_mfma_f32_16x16x32_bf16 v[148:151], v[196:199], a[68:71], v[148:151]
    v_mfma_f32_16x16x32_bf16 v[152:155], v[184:187], a[72:75], v[152:155]
    buffer_load_dwordx4 v233, s[16:19], s81 offen offset:1056 lds
    v_mfma_f32_16x16x32_bf16 v[156:159], v[188:191], a[72:75], v[156:159]
    v_mfma_f32_16x16x32_bf16 v[160:163], v[192:195], a[72:75], v[160:163]
    v_mfma_f32_16x16x32_bf16 v[164:167], v[196:199], a[72:75], v[164:167]
    s_waitcnt lgkmcnt(0)
    v_mfma_f32_16x16x32_bf16 v[168:171], v[200:203], a[76:79], v[168:171]
    buffer_load_dwordx4 v234, s[16:19], s81 offen offset:2112 lds
    s_mov_b32 s49, 0x1000
    v_mfma_f32_16x16x32_bf16 v[172:175], v[204:207], a[76:79], v[172:175]
    ds_read_b128 a[152:155], v237 offset:18432
    s_mov_b32 s50, 0x2000
    v_mfma_f32_16x16x32_bf16 v[176:179], v[208:211], a[76:79], v[176:179]
    ds_read_b128 a[156:159], v238 offset:2048
    s_lshl_b32 s52, s35, 18
    v_mfma_f32_16x16x32_bf16 v[180:183], v[212:215], a[76:79], v[180:183]
    ds_read_b128 a[160:163], v238 offset:6144
    s_xor_b32 s53, s52, 0x40000
    v_mfma_f32_16x16x32_bf16 v[104:107], v[200:203], a[80:83], v[104:107]
    buffer_load_dwordx4 v235, s[16:19], s81 offen offset:3168 lds
    s_waitcnt vmcnt(18)
    v_mfma_f32_16x16x32_bf16 v[108:111], v[204:207], a[80:83], v[108:111]
    ds_read_b64_tr_b16 v[24:25], v222 offset:50688
    ds_read_b64_tr_b16 v[28:29], v223 offset:50688
    v_mfma_f32_16x16x32_bf16 v[112:115], v[208:211], a[80:83], v[112:115]
    ds_read_b64_tr_b16 v[32:33], v224 offset:50688
    ds_read_b64_tr_b16 v[36:37], v225 offset:50688
    v_mfma_f32_16x16x32_bf16 v[116:119], v[212:215], a[80:83], v[116:119]
    ds_read_b128 a[164:167], v238 offset:10240
    s_add_u32 m0, s40, 0xc600
    v_mfma_f32_16x16x32_bf16 v[120:123], v[200:203], a[84:87], v[120:123]
    s_add_u32 s81, s81, 0x40000
    s_and_b32 s81, s81, 0x3fffff
    s_mov_b32 s62, 0x4b800000
    v_mfma_f32_16x16x32_bf16 v[124:127], v[204:207], a[84:87], v[124:127]
    buffer_load_dwordx4 v232, s[16:19], s81 offen lds
    v_accvgpr_write_b32 a48, 0
    v_mfma_f32_16x16x32_bf16 v[128:131], v[208:211], a[84:87], v[128:131]
    ds_read_b128 a[168:171], v238 offset:14336
    v_accvgpr_write_b32 a49, 0
    v_mfma_f32_16x16x32_bf16 v[132:135], v[212:215], a[84:87], v[132:135]
    ds_read_b128 a[172:175], v238 offset:18432
    v_accvgpr_write_b32 a50, 0
    v_mfma_f32_16x16x32_bf16 v[136:139], v[200:203], a[88:91], v[136:139]
    ds_read_b128 a[208:211], v239
    v_accvgpr_write_b32 a51, 0
    v_mfma_f32_16x16x32_bf16 v[140:143], v[204:207], a[88:91], v[140:143]
    buffer_load_dwordx4 v233, s[16:19], s81 offen offset:1056 lds
    s_waitcnt vmcnt(18)
    v_mfma_f32_16x16x32_bf16 v[144:147], v[208:211], a[88:91], v[144:147]
    ds_read_b64_tr_b16 v[26:27], v222 offset:52800
    ds_read_b64_tr_b16 v[30:31], v223 offset:52800
    v_mfma_f32_16x16x32_bf16 v[148:151], v[212:215], a[88:91], v[148:151]
    ds_read_b64_tr_b16 v[34:35], v224 offset:52800
    ds_read_b64_tr_b16 v[38:39], v225 offset:52800
    v_mfma_f32_16x16x32_bf16 v[152:155], v[200:203], a[92:95], v[152:155]
    buffer_load_dwordx4 v234, s[16:19], s81 offen offset:2112 lds
    v_accvgpr_write_b32 a52, 0
    v_mfma_f32_16x16x32_bf16 v[156:159], v[204:207], a[92:95], v[156:159]
    v_accvgpr_write_b32 a53, 0
    v_accvgpr_write_b32 a54, 0
    v_mfma_f32_16x16x32_bf16 v[160:163], v[208:211], a[92:95], v[160:163]
    v_accvgpr_write_b32 a55, 0
    v_accvgpr_write_b32 a56, 0
    v_mfma_f32_16x16x32_bf16 v[164:167], v[212:215], a[92:95], v[164:167]
    v_accvgpr_write_b32 a57, 0
    v_accvgpr_write_b32 a58, 0
    s_waitcnt lgkmcnt(0)
    s_barrier
    v_mfma_f32_16x16x32_bf16 v[168:171], v[24:27], a[96:99], v[168:171]
    buffer_load_dwordx4 v235, s[16:19], s81 offen offset:3168 lds
    s_add_u32 m0, s40, 0x1ce00
    v_mfma_f32_16x16x32_bf16 v[172:175], v[28:31], a[96:99], v[172:175]
    ds_read_b128 a[212:215], v239 offset:4096
    s_add_u32 s81, s81, 0x40000
    v_mfma_f32_16x16x32_bf16 v[176:179], v[32:35], a[96:99], v[176:179]
    ds_read_b128 a[216:219], v239 offset:8192
    s_and_b32 s81, s81, 0x3fffff
    v_mfma_f32_16x16x32_bf16 v[180:183], v[36:39], a[96:99], v[180:183]
    ds_read_b128 a[220:223], v239 offset:12288
    v_accvgpr_write_b32 a59, 0
    v_mfma_f32_16x16x32_bf16 v[104:107], v[24:27], a[100:103], v[104:107]
    buffer_load_dwordx4 v232, s[16:19], s81 offen lds
    s_waitcnt vmcnt(19)
    v_mfma_f32_16x16x32_bf16 v[108:111], v[28:31], a[100:103], v[108:111]
    ds_read_b64_tr_b16 v[184:185], v222
    ds_read_b64_tr_b16 v[188:189], v223
    v_mfma_f32_16x16x32_bf16 v[112:115], v[32:35], a[100:103], v[112:115]
    ds_read_b64_tr_b16 v[192:193], v224
    ds_read_b64_tr_b16 v[196:197], v225
    v_mfma_f32_16x16x32_bf16 v[116:119], v[36:39], a[100:103], v[116:119]
    ds_read_b128 a[0:3], v239 offset:16384
    v_accvgpr_write_b32 a60, 0
    v_mfma_f32_16x16x32_bf16 v[120:123], v[24:27], a[104:107], v[120:123]
    buffer_load_dwordx4 v233, s[16:19], s81 offen offset:1056 lds
    v_accvgpr_write_b32 a61, 0
    v_mfma_f32_16x16x32_bf16 v[124:127], v[28:31], a[104:107], v[124:127]
    ds_read_b128 a[4:7], v240
    v_accvgpr_write_b32 a62, 0
    v_mfma_f32_16x16x32_bf16 v[128:131], v[32:35], a[104:107], v[128:131]
    ds_read_b128 a[8:11], v240 offset:4096
    v_accvgpr_write_b32 a63, 0
    v_mfma_f32_16x16x32_bf16 v[132:135], v[36:39], a[104:107], v[132:135]
    ds_read_b128 a[12:15], v240 offset:8192
    v_accvgpr_write_b32 a64, 0
    v_mfma_f32_16x16x32_bf16 v[136:139], v[24:27], a[108:111], v[136:139]
    buffer_load_dwordx4 v234, s[16:19], s81 offen offset:2112 lds
    s_waitcnt vmcnt(19)
    v_mfma_f32_16x16x32_bf16 v[140:143], v[28:31], a[108:111], v[140:143]
    ds_read_b64_tr_b16 v[186:187], v222 offset:2112
    ds_read_b64_tr_b16 v[190:191], v223 offset:2112
    v_mfma_f32_16x16x32_bf16 v[144:147], v[32:35], a[108:111], v[144:147]
    ds_read_b64_tr_b16 v[194:195], v224 offset:2112
    ds_read_b64_tr_b16 v[198:199], v225 offset:2112
    v_mfma_f32_16x16x32_bf16 v[148:151], v[36:39], a[108:111], v[148:151]
    v_accvgpr_write_b32 a65, 0
    v_accvgpr_write_b32 a66, 0
    v_mfma_f32_16x16x32_bf16 v[152:155], v[24:27], a[112:115], v[152:155]
    buffer_load_dwordx4 v235, s[16:19], s81 offen offset:3168 lds
    v_accvgpr_write_b32 a67, 0
    v_mfma_f32_16x16x32_bf16 v[156:159], v[28:31], a[112:115], v[156:159]
    v_accvgpr_write_b32 a68, 0
    v_accvgpr_write_b32 a69, 0
    v_mfma_f32_16x16x32_bf16 v[160:163], v[32:35], a[112:115], v[160:163]
    v_accvgpr_write_b32 a70, 0
    v_accvgpr_write_b32 a71, 0
    v_mfma_f32_16x16x32_bf16 v[164:167], v[36:39], a[112:115], v[164:167]
    v_accvgpr_write_b32 a72, 0
    v_accvgpr_write_b32 a73, 0
    s_waitcnt lgkmcnt(0)
    v_mfma_f32_16x16x32_bf16 v[168:171], v[184:187], a[116:119], v[168:171]
    s_add_u32 m0, s40, 0x10800
    s_add_u32 s81, s81, 0x40000
    s_and_b32 s81, s81, 0x3fffff
    v_mfma_f32_16x16x32_bf16 v[172:175], v[188:191], a[116:119], v[172:175]
    buffer_load_dwordx4 v232, s[16:19], s81 offen lds
    v_accvgpr_write_b32 a74, 0
    v_mfma_f32_16x16x32_bf16 v[176:179], v[192:195], a[116:119], v[176:179]
    ds_read_b128 a[16:19], v240 offset:12288
    v_accvgpr_write_b32 a75, 0
    v_mfma_f32_16x16x32_bf16 v[180:183], v[196:199], a[116:119], v[180:183]
    buffer_load_dwordx4 v233, s[16:19], s81 offen offset:1056 lds
    s_waitcnt vmcnt(20)
    v_mfma_f32_16x16x32_bf16 v[104:107], v[184:187], a[120:123], v[104:107]
    ds_read_b64_tr_b16 v[200:201], v222 offset:16896
    ds_read_b64_tr_b16 v[204:205], v223 offset:16896
    v_mfma_f32_16x16x32_bf16 v[108:111], v[188:191], a[120:123], v[108:111]
    ds_read_b64_tr_b16 v[208:209], v224 offset:16896
    ds_read_b64_tr_b16 v[212:213], v225 offset:16896
    v_mfma_f32_16x16x32_bf16 v[112:115], v[192:195], a[120:123], v[112:115]
    buffer_load_dwordx4 v234, s[16:19], s81 offen offset:2112 lds
    v_accvgpr_write_b32 a76, 0
    v_mfma_f32_16x16x32_bf16 v[116:119], v[196:199], a[120:123], v[116:119]
    ds_read_b128 a[20:23], v240 offset:16384
    v_accvgpr_write_b32 a77, 0
    v_mfma_f32_16x16x32_bf16 v[120:123], v[184:187], a[124:127], v[120:123]
    buffer_load_dwordx4 v235, s[16:19], s81 offen offset:3168 lds
    s_waitcnt vmcnt(20)
    v_mfma_f32_16x16x32_bf16 v[124:127], v[188:191], a[124:127], v[124:127]
    ds_read_b64_tr_b16 v[202:203], v222 offset:19008
    ds_read_b64_tr_b16 v[206:207], v223 offset:19008
    v_mfma_f32_16x16x32_bf16 v[128:131], v[192:195], a[124:127], v[128:131]
    ds_read_b64_tr_b16 v[210:211], v224 offset:19008
    ds_read_b64_tr_b16 v[214:215], v225 offset:19008
    v_mfma_f32_16x16x32_bf16 v[132:135], v[196:199], a[124:127], v[132:135]
    s_mov_b32 s80, 0
    s_add_u32 m0, s40, 0
    v_accvgpr_write_b32 a78, 0
    v_mfma_f32_16x16x32_bf16 v[136:139], v[184:187], a[128:131], v[136:139]
    buffer_load_dwordx4 v2, s[8:11], s80 offen nt lds
    v_accvgpr_write_b32 a79, 0
    v_mfma_f32_16x16x32_bf16 v[140:143], v[188:191], a[128:131], v[140:143]
    ds_read_b128 a[24:27], v239 offset:2048
    v_mov_b32 v241, 0
    v_mfma_f32_16x16x32_bf16 v[144:147], v[192:195], a[128:131], v[144:147]
    buffer_load_dwordx4 v3, s[8:11], s80 offen offset:1056 nt lds
    v_mov_b32 v242, 0
    v_mfma_f32_16x16x32_bf16 v[148:151], v[196:199], a[128:131], v[148:151]
    ds_read_b128 a[28:31], v239 offset:6144
    v_mov_b32 v243, 0
    v_mfma_f32_16x16x32_bf16 v[152:155], v[184:187], a[132:135], v[152:155]
    buffer_load_dwordx4 v4, s[8:11], s80 offen offset:2112 nt lds
    v_bfe_u32 v16, v1, 4, 1
    v_mfma_f32_16x16x32_bf16 v[156:159], v[188:191], a[132:135], v[156:159]
    ds_read_b128 a[32:35], v239 offset:10240
    v_mul_u32_u24 v16, 43690, v16
    v_mfma_f32_16x16x32_bf16 v[160:163], v[192:195], a[132:135], v[160:163]
    buffer_load_dwordx4 v5, s[8:11], s80 offen offset:3168 nt lds
    v_add_u32 v16, 17476, v16
    v_mfma_f32_16x16x32_bf16 v[164:167], v[196:199], a[132:135], v[164:167]
    v_mov_b32 v236, 0
    v_lshrrev_b32 v231, 2, v1
    s_waitcnt lgkmcnt(3)
    v_mfma_f32_16x16x32_bf16 v[168:171], v[200:203], a[136:139], v[168:171]
    s_add_u32 m0, s40, 0x4200
    s_mov_b32 s80, 0
    v_mul_u32_u24 v231, 5, v231
    v_mfma_f32_16x16x32_bf16 v[172:175], v[204:207], a[136:139], v[172:175]
    buffer_load_dwordx4 v2, s[12:15], s80 offen nt lds
    s_add_u32 s38, s38, s39
    v_mfma_f32_16x16x32_bf16 v[176:179], v[208:211], a[136:139], v[176:179]
    ds_read_b128 a[36:39], v239 offset:14336
    v_mov_b32 v234, 1
    v_mfma_f32_16x16x32_bf16 v[180:183], v[212:215], a[136:139], v[180:183]
    ds_read_b128 a[40:43], v239 offset:18432
    v_mfma_f32_16x16x32_bf16 v[104:107], v[200:203], a[140:143], v[104:107]
    ds_read_b128 a[44:47], v240 offset:2048
    v_mfma_f32_16x16x32_bf16 v[108:111], v[204:207], a[140:143], v[108:111]
    buffer_load_dwordx4 v3, s[12:15], s80 offen offset:1056 nt lds
    s_waitcnt vmcnt(24)
    v_mfma_f32_16x16x32_bf16 v[112:115], v[208:211], a[140:143], v[112:115]
    ds_read_b64_tr_b16 v[24:25], v12 offset:33792
    ds_read_b64_tr_b16 v[28:29], v13 offset:33792
    v_mfma_f32_16x16x32_bf16 v[116:119], v[212:215], a[140:143], v[116:119]
    ds_read_b64_tr_b16 v[32:33], v14 offset:33792
    ds_read_b64_tr_b16 v[36:37], v15 offset:33792
    v_mfma_f32_16x16x32_bf16 v[120:123], v[200:203], a[144:147], v[120:123]
    s_waitcnt vmcnt(37)
    v_xor_b32 v18, 2147516416, v18
    v_mfma_f32_16x16x32_bf16 v[124:127], v[204:207], a[144:147], v[124:127]
    ds_write_b32 v255, v18
    v_mfma_f32_16x16x32_bf16 v[128:131], v[208:211], a[144:147], v[128:131]
    ds_read_b128 v[40:43], v240 offset:6144
    v_mfma_f32_16x16x32_bf16 v[132:135], v[212:215], a[144:147], v[132:135]
    buffer_load_dwordx4 v4, s[12:15], s80 offen offset:2112 nt lds
    v_mfma_f32_16x16x32_bf16 v[136:139], v[200:203], a[148:151], v[136:139]
    buffer_load_dwordx4 v5, s[12:15], s80 offen offset:3168 nt lds
    s_waitcnt vmcnt(24)
    v_mfma_f32_16x16x32_bf16 v[140:143], v[204:207], a[148:151], v[140:143]
    ds_read_b64_tr_b16 v[26:27], v12 offset:35904
    ds_read_b64_tr_b16 v[30:31], v13 offset:35904
    v_mfma_f32_16x16x32_bf16 v[144:147], v[208:211], a[148:151], v[144:147]
    ds_read_b64_tr_b16 v[34:35], v14 offset:35904
    ds_read_b64_tr_b16 v[38:39], v15 offset:35904
    v_mfma_f32_16x16x32_bf16 v[148:151], v[212:215], a[148:151], v[148:151]
    ds_read_b128 v[56:59], v254
    v_mfma_f32_16x16x32_bf16 v[152:155], v[200:203], a[152:155], v[152:155]
    ds_read_b128 v[60:63], v254 offset:64
    v_mfma_f32_16x16x32_bf16 v[156:159], v[204:207], a[152:155], v[156:159]
    ds_read_b128 v[64:67], v254 offset:128
    v_mfma_f32_16x16x32_bf16 v[160:163], v[208:211], a[152:155], v[160:163]
    ds_read_b128 v[68:71], v254 offset:192
    v_mfma_f32_16x16x32_bf16 v[164:167], v[212:215], a[152:155], v[164:167]
    s_waitcnt lgkmcnt(4)
    v_mfma_f32_16x16x32_bf16 v[168:171], v[24:27], a[156:159], v[168:171]
    s_add_u32 m0, s40, 0x8400
    s_mov_b32 s80, 0x4000
    v_mfma_f32_16x16x32_bf16 v[172:175], v[28:31], a[156:159], v[172:175]
    buffer_load_dwordx4 v2, s[8:11], s80 offen nt lds
    s_waitcnt vmcnt(21)
    v_mfma_f32_16x16x32_bf16 v[176:179], v[32:35], a[156:159], v[176:179]
    ds_read_b64_tr_b16 v[184:185], v222 offset:33792
    ds_read_b64_tr_b16 v[186:187], v222 offset:35904
    v_mfma_f32_16x16x32_bf16 v[180:183], v[36:39], a[156:159], v[180:183]
    ds_read_b64_tr_b16 v[188:189], v223 offset:33792
    ds_read_b64_tr_b16 v[190:191], v223 offset:35904
    v_mfma_f32_16x16x32_bf16 v[104:107], v[24:27], a[160:163], v[104:107]
    ds_read_b64_tr_b16 v[192:193], v224 offset:33792
    ds_read_b64_tr_b16 v[194:195], v224 offset:35904
    v_mfma_f32_16x16x32_bf16 v[108:111], v[28:31], a[160:163], v[108:111]
    ds_read_b64_tr_b16 v[196:197], v225 offset:33792
    ds_read_b64_tr_b16 v[198:199], v225 offset:35904
    v_mfma_f32_16x16x32_bf16 v[112:115], v[32:35], a[160:163], v[112:115]
    ds_read_b128 v[44:47], v240 offset:10240
    v_mfma_f32_16x16x32_bf16 v[116:119], v[36:39], a[160:163], v[116:119]
    buffer_load_dwordx4 v3, s[8:11], s80 offen offset:1056 nt lds
    v_mfma_f32_16x16x32_bf16 v[120:123], v[24:27], a[164:167], v[120:123]
    ds_read_b128 v[48:51], v240 offset:14336
    v_mfma_f32_16x16x32_bf16 v[124:127], v[28:31], a[164:167], v[124:127]
    ds_read_b128 v[52:55], v240 offset:18432
    v_mfma_f32_16x16x32_bf16 v[128:131], v[32:35], a[164:167], v[128:131]
    buffer_load_dwordx4 v4, s[8:11], s80 offen offset:2112 nt lds
    v_mfma_f32_16x16x32_bf16 v[132:135], v[36:39], a[164:167], v[132:135]
    v_mfma_f32_16x16x32_bf16 v[136:139], v[24:27], a[168:171], v[136:139]
    buffer_load_dwordx4 v5, s[8:11], s80 offen offset:3168 nt lds
    s_waitcnt vmcnt(20)
    v_mfma_f32_16x16x32_bf16 v[140:143], v[28:31], a[168:171], v[140:143]
    ds_read_b64_tr_b16 v[200:201], v12 offset:50688
    ds_read_b64_tr_b16 v[202:203], v12 offset:52800
    v_mfma_f32_16x16x32_bf16 v[144:147], v[32:35], a[168:171], v[144:147]
    ds_read_b64_tr_b16 v[204:205], v13 offset:50688
    ds_read_b64_tr_b16 v[206:207], v13 offset:52800
    v_mfma_f32_16x16x32_bf16 v[148:151], v[36:39], a[168:171], v[148:151]
    ds_read_b64_tr_b16 v[208:209], v14 offset:50688
    ds_read_b64_tr_b16 v[210:211], v14 offset:52800
    v_mfma_f32_16x16x32_bf16 v[152:155], v[24:27], a[172:175], v[152:155]
    ds_read_b64_tr_b16 v[212:213], v15 offset:50688
    ds_read_b64_tr_b16 v[214:215], v15 offset:52800
    v_mfma_f32_16x16x32_bf16 v[156:159], v[28:31], a[172:175], v[156:159]
    v_mfma_f32_16x16x32_bf16 v[160:163], v[32:35], a[172:175], v[160:163]
    v_mfma_f32_16x16x32_bf16 v[164:167], v[36:39], a[172:175], v[164:167]
    s_waitcnt lgkmcnt(11)
    v_mfma_f32_16x16x32_bf16 v[168:171], v[184:187], a[208:211], v[168:171]
    s_waitcnt vmcnt(16)
    ds_read_b64_tr_b16 a[192:193], v222 offset:50688
    v_mfma_f32_16x16x32_bf16 v[172:175], v[188:191], a[208:211], v[172:175]
    ds_read_b64_tr_b16 a[194:195], v222 offset:52800
    ds_read_b64_tr_b16 a[196:197], v223 offset:50688
    v_mfma_f32_16x16x32_bf16 v[176:179], v[192:195], a[208:211], v[176:179]
    ds_read_b64_tr_b16 a[198:199], v223 offset:52800
    ds_read_b64_tr_b16 a[200:201], v224 offset:50688
    v_mfma_f32_16x16x32_bf16 v[180:183], v[196:199], a[208:211], v[180:183]
    ds_read_b64_tr_b16 a[202:203], v224 offset:52800
    ds_read_b64_tr_b16 a[204:205], v225 offset:50688
    s_waitcnt lgkmcnt(7)
    v_mfma_f32_16x16x32_bf16 v[168:171], v[200:203], a[4:7], v[168:171]
    ds_read_b64_tr_b16 a[206:207], v225 offset:52800
    s_waitcnt vmcnt(12)
    v_mfma_f32_16x16x32_bf16 v[172:175], v[204:207], a[4:7], v[172:175]
    s_add_u32 m0, s40, 0xc600
    s_mov_b32 s80, 0x4000
    v_mov_b32 v240, 0
    v_mfma_f32_16x16x32_bf16 v[176:179], v[208:211], a[4:7], v[176:179]
    ds_read_b64_tr_b16 v[24:25], v222
    ds_read_b64_tr_b16 v[26:27], v222 offset:2112
    v_mfma_f32_16x16x32_bf16 v[180:183], v[212:215], a[4:7], v[180:183]
    ds_read_b64_tr_b16 v[28:29], v223
    ds_read_b64_tr_b16 v[30:31], v223 offset:2112
    s_waitcnt lgkmcnt(4)
    v_mfma_f32_16x16x32_bf16 v[168:171], a[192:195], a[24:27], v[168:171]
    buffer_load_dwordx4 v2, s[12:15], s80 offen nt lds
    v_mov_b32 v237, 2004318071
    v_mfma_f32_16x16x32_bf16 v[172:175], a[196:199], a[24:27], v[172:175]
    ds_read_b64_tr_b16 v[32:33], v224
    ds_read_b64_tr_b16 v[34:35], v224 offset:2112
    v_mfma_f32_16x16x32_bf16 v[176:179], a[200:203], a[24:27], v[176:179]
    ds_read_b64_tr_b16 v[36:37], v225
    ds_read_b64_tr_b16 v[38:39], v225 offset:2112
    v_mfma_f32_16x16x32_bf16 v[180:183], a[204:207], a[24:27], v[180:183]
    buffer_load_dwordx4 v3, s[12:15], s80 offen offset:1056 nt lds
    s_waitcnt lgkmcnt(0)
    v_mfma_f32_16x16x32_bf16 v[168:171], v[24:27], a[44:47], v[168:171]
    v_mfma_f32_16x16x32_bf16 v[172:175], v[28:31], a[44:47], v[172:175]
    v_mfma_f32_16x16x32_bf16 v[176:179], v[32:35], a[44:47], v[176:179]
    buffer_load_dwordx4 v4, s[12:15], s80 offen offset:2112 nt lds
    v_mul_f32 v168, s74, v168
    v_mfma_f32_16x16x32_bf16 v[180:183], v[36:39], a[44:47], v[180:183]
    v_mul_f32 v169, s74, v169
    v_mul_f32 v170, s74, v170
    v_mul_f32 v171, s74, v171
    v_mfma_f32_16x16x32_bf16 v[104:107], v[184:187], a[212:215], v[104:107]
    v_cvt_pk_bf16_f32 v168, v168, v169
    v_cvt_pk_bf16_f32 v169, v170, v171
    v_mul_f32 v172, s74, v172
    v_mfma_f32_16x16x32_bf16 v[104:107], v[200:203], a[8:11], v[104:107]
    ds_write_b64 v21, v[168:169]
    v_mul_f32 v173, s74, v173
    v_mfma_f32_16x16x32_bf16 v[104:107], a[192:195], a[28:31], v[104:107]
    v_mul_f32 v174, s74, v174
    v_mul_f32 v175, s74, v175
    v_cvt_pk_bf16_f32 v172, v172, v173
    v_mfma_f32_16x16x32_bf16 v[104:107], v[24:27], v[40:43], v[104:107]
    buffer_load_dwordx4 v5, s[12:15], s80 offen offset:3168 nt lds
    v_cvt_pk_bf16_f32 v173, v174, v175
    v_mfma_f32_16x16x32_bf16 v[108:111], v[188:191], a[212:215], v[108:111]
    ds_write_b64 v21, v[172:173] offset:512
    v_mul_f32 v176, s74, v176
    v_mfma_f32_16x16x32_bf16 v[108:111], v[204:207], a[8:11], v[108:111]
    v_mul_f32 v177, s74, v177
    v_mul_f32 v178, s74, v178
    v_mul_f32 v179, s74, v179
    v_mfma_f32_16x16x32_bf16 v[108:111], a[196:199], a[28:31], v[108:111]
    s_add_u32 m0, s40, 0x10800
    s_mov_b32 s80, 0x8000
    v_cvt_pk_bf16_f32 v176, v176, v177
    v_mfma_f32_16x16x32_bf16 v[108:111], v[28:31], v[40:43], v[108:111]
    v_cvt_pk_bf16_f32 v177, v178, v179
    ds_write_b64 v21, v[176:177] offset:1024
    v_mfma_f32_16x16x32_bf16 v[112:115], v[192:195], a[212:215], v[112:115]
    buffer_load_dwordx4 v2, s[8:11], s80 offen nt lds
    v_mul_f32 v180, s74, v180
    v_mfma_f32_16x16x32_bf16 v[112:115], v[208:211], a[8:11], v[112:115]
    v_mul_f32 v181, s74, v181
    v_mul_f32 v182, s74, v182
    v_mul_f32 v183, s74, v183
    v_mfma_f32_16x16x32_bf16 v[112:115], a[200:203], a[28:31], v[112:115]
    v_cvt_pk_bf16_f32 v180, v180, v181
    v_cvt_pk_bf16_f32 v181, v182, v183
    v_mul_f32 v104, s74, v104
    v_mfma_f32_16x16x32_bf16 v[112:115], v[32:35], v[40:43], v[112:115]
    ds_write_b64 v21, v[180:181] offset:1536
    v_mul_f32 v105, s74, v105
    v_mfma_f32_16x16x32_bf16 v[116:119], v[196:199], a[212:215], v[116:119]
    v_mul_f32 v106, s74, v106
    v_mul_f32 v107, s74, v107
    v_cvt_pk_bf16_f32 v104, v104, v105
    v_mfma_f32_16x16x32_bf16 v[116:119], v[212:215], a[8:11], v[116:119]
    buffer_load_dwordx4 v3, s[8:11], s80 offen offset:1056 nt lds
    v_cvt_pk_bf16_f32 v105, v106, v107
    v_mfma_f32_16x16x32_bf16 v[116:119], a[204:207], a[28:31], v[116:119]
    ds_write_b64 v21, v[104:105] offset:2048
    v_mul_f32 v108, s74, v108
    v_mfma_f32_16x16x32_bf16 v[116:119], v[36:39], v[40:43], v[116:119]
    v_mul_f32 v109, s74, v109
    v_mul_f32 v110, s74, v110
    v_mul_f32 v111, s74, v111
    v_mfma_f32_16x16x32_bf16 v[120:123], v[184:187], a[216:219], v[120:123]
    v_cvt_pk_bf16_f32 v108, v108, v109
    v_cvt_pk_bf16_f32 v109, v110, v111
    v_mul_f32 v112, s74, v112
    v_mfma_f32_16x16x32_bf16 v[120:123], v[200:203], a[12:15], v[120:123]
    ds_write_b64 v21, v[108:109] offset:2560
    v_mul_f32 v113, s74, v113
    v_mfma_f32_16x16x32_bf16 v[120:123], a[192:195], a[32:35], v[120:123]
    buffer_load_dwordx4 v4, s[8:11], s80 offen offset:2112 nt lds
    v_mul_f32 v114, s74, v114
    v_mfma_f32_16x16x32_bf16 v[120:123], v[24:27], v[44:47], v[120:123]
    v_mul_f32 v115, s74, v115
    v_cvt_pk_bf16_f32 v112, v112, v113
    v_cvt_pk_bf16_f32 v113, v114, v115
    v_mfma_f32_16x16x32_bf16 v[124:127], v[188:191], a[216:219], v[124:127]
    ds_write_b64 v21, v[112:113] offset:3072
    v_mul_f32 v116, s74, v116
    v_mfma_f32_16x16x32_bf16 v[124:127], v[204:207], a[12:15], v[124:127]
    v_mul_f32 v117, s74, v117
    v_mul_f32 v118, s74, v118
    v_mul_f32 v119, s74, v119
    v_mfma_f32_16x16x32_bf16 v[124:127], a[196:199], a[32:35], v[124:127]
    v_cvt_pk_bf16_f32 v116, v116, v117
    v_cvt_pk_bf16_f32 v117, v118, v119
    v_mul_f32 v120, s74, v120
    v_mfma_f32_16x16x32_bf16 v[124:127], v[28:31], v[44:47], v[124:127]
    buffer_load_dwordx4 v5, s[8:11], s80 offen offset:3168 nt lds
    v_mul_f32 v121, s74, v121
    v_mfma_f32_16x16x32_bf16 v[128:131], v[192:195], a[216:219], v[128:131]
    ds_write_b64 v21, v[116:117] offset:3584
    v_mul_f32 v122, s74, v122
    v_mfma_f32_16x16x32_bf16 v[128:131], v[208:211], a[12:15], v[128:131]
    v_mul_f32 v123, s74, v123
    v_cvt_pk_bf16_f32 v120, v120, v121
    v_cvt_pk_bf16_f32 v121, v122, v123
    v_mfma_f32_16x16x32_bf16 v[128:131], a[200:203], a[32:35], v[128:131]
    s_add_u32 m0, s40, 0x14a00
    s_mov_b32 s80, 0x8000
    v_mul_f32 v124, s74, v124
    v_mfma_f32_16x16x32_bf16 v[128:131], v[32:35], v[44:47], v[128:131]
    v_mul_f32 v125, s74, v125
    v_mul_f32 v126, s74, v126
    v_mul_f32 v127, s74, v127
    v_mfma_f32_16x16x32_bf16 v[132:135], v[196:199], a[216:219], v[132:135]
    s_waitcnt vmcnt(16) lgkmcnt(0)
    s_barrier
    v_cvt_pk_bf16_f32 v124, v124, v125
    v_mfma_f32_16x16x32_bf16 v[132:135], v[212:215], a[12:15], v[132:135]
    buffer_load_dwordx4 v2, s[12:15], s80 offen nt lds
    v_cvt_pk_bf16_f32 v125, v126, v127
    v_mfma_f32_16x16x32_bf16 v[132:135], a[204:207], a[32:35], v[132:135]
    ds_write_b64 v17, v[120:121]
    v_mul_f32 v128, s74, v128
    v_mfma_f32_16x16x32_bf16 v[132:135], v[36:39], v[44:47], v[132:135]
    ds_write_b64 v17, v[124:125] offset:512
    v_mul_f32 v129, s74, v129
    v_mfma_f32_16x16x32_bf16 v[136:139], v[184:187], a[220:223], v[136:139]
    ds_read_b128 a[80:83], v22
    ds_read_b128 a[84:87], v22 offset:1024
    v_mfma_f32_16x16x32_bf16 v[136:139], v[200:203], a[16:19], v[136:139]
    buffer_load_dwordx4 v3, s[12:15], s80 offen offset:1056 nt lds
    v_mul_f32 v130, s74, v130
    v_mfma_f32_16x16x32_bf16 v[136:139], a[192:195], a[36:39], v[136:139]
    ds_read_b128 a[88:91], v22 offset:8448
    ds_read_b128 a[92:95], v22 offset:9472
    v_mfma_f32_16x16x32_bf16 v[136:139], v[24:27], v[48:51], v[136:139]
    ds_read_b128 a[96:99], v22 offset:2048
    ds_read_b128 a[100:103], v22 offset:3072
    v_mfma_f32_16x16x32_bf16 v[140:143], v[188:191], a[220:223], v[140:143]
    ds_read_b128 a[104:107], v22 offset:10496
    ds_read_b128 a[108:111], v22 offset:11520
    v_mfma_f32_16x16x32_bf16 v[140:143], v[204:207], a[16:19], v[140:143]
    v_mul_f32 v131, s74, v131
    ds_read_b128 a[160:163], v6
    v_mfma_f32_16x16x32_bf16 v[140:143], a[196:199], a[36:39], v[140:143]
    v_cvt_pk_bf16_f32 v128, v128, v129
    v_cvt_pk_bf16_f32 v129, v130, v131
    v_mul_f32 v132, s74, v132
    v_mfma_f32_16x16x32_bf16 v[140:143], v[28:31], v[48:51], v[140:143]
    ds_write_b64 v17, v[128:129] offset:1024
    v_mul_f32 v133, s74, v133
    v_mfma_f32_16x16x32_bf16 v[144:147], v[192:195], a[220:223], v[144:147]
    v_mul_f32 v134, s74, v134
    v_mul_f32 v135, s74, v135
    v_cvt_pk_bf16_f32 v132, v132, v133
    v_mfma_f32_16x16x32_bf16 v[144:147], v[208:211], a[16:19], v[144:147]
    buffer_load_dwordx4 v4, s[12:15], s80 offen offset:2112 nt lds
    v_cvt_pk_bf16_f32 v133, v134, v135
    v_mfma_f32_16x16x32_bf16 v[144:147], a[200:203], a[36:39], v[144:147]
    ds_write_b64 v17, v[132:133] offset:1536
    v_mul_f32 v136, s74, v136
    v_mfma_f32_16x16x32_bf16 v[144:147], v[32:35], v[48:51], v[144:147]
    v_mul_f32 v137, s74, v137
    v_mul_f32 v138, s74, v138
    v_mul_f32 v139, s74, v139
    v_mfma_f32_16x16x32_bf16 v[148:151], v[196:199], a[220:223], v[148:151]
    v_cvt_pk_bf16_f32 v136, v136, v137
    v_cvt_pk_bf16_f32 v137, v138, v139
    v_mul_f32 v140, s74, v140
    v_mfma_f32_16x16x32_bf16 v[148:151], v[212:215], a[16:19], v[148:151]
    ds_write_b64 v17, v[136:137] offset:2048
    v_mul_f32 v141, s74, v141
    v_mfma_f32_16x16x32_bf16 v[148:151], a[204:207], a[36:39], v[148:151]
    buffer_load_dwordx4 v5, s[12:15], s80 offen offset:3168 nt lds
    v_mul_f32 v142, s74, v142
    v_mfma_f32_16x16x32_bf16 v[148:151], v[36:39], v[48:51], v[148:151]
    v_mul_f32 v143, s74, v143
    v_cvt_pk_bf16_f32 v140, v140, v141
    v_cvt_pk_bf16_f32 v141, v142, v143
    v_mfma_f32_16x16x32_bf16 v[152:155], v[184:187], a[0:3], v[152:155]
    ds_write_b64 v17, v[140:141] offset:2560
    v_mul_f32 v144, s74, v144
    v_mfma_f32_16x16x32_bf16 v[152:155], v[200:203], a[20:23], v[152:155]
    s_add_u32 m0, s40, 0x18c00
    s_mov_b32 s80, 0xc000
    v_mul_f32 v145, s74, v145
    v_mfma_f32_16x16x32_bf16 v[152:155], a[192:195], a[40:43], v[152:155]
    v_mul_f32 v146, s74, v146
    v_mul_f32 v147, s74, v147
    v_cvt_pk_bf16_f32 v144, v144, v145
    v_mfma_f32_16x16x32_bf16 v[152:155], v[24:27], v[52:55], v[152:155]
    v_cvt_pk_bf16_f32 v145, v146, v147
    buffer_load_dwordx4 v2, s[8:11], s80 offen nt lds
    v_mfma_f32_16x16x32_bf16 v[156:159], v[188:191], a[0:3], v[156:159]
    ds_write_b64 v17, v[144:145] offset:3072
    v_mul_f32 v148, s74, v148
    v_mfma_f32_16x16x32_bf16 v[156:159], v[204:207], a[20:23], v[156:159]
    v_mul_f32 v149, s74, v149
    v_mul_f32 v150, s74, v150
    v_mul_f32 v151, s74, v151
    v_mfma_f32_16x16x32_bf16 v[156:159], a[196:199], a[40:43], v[156:159]
    v_cvt_pk_bf16_f32 v148, v148, v149
    v_cvt_pk_bf16_f32 v149, v150, v151
    v_mul_f32 v152, s74, v152
    v_mfma_f32_16x16x32_bf16 v[156:159], v[28:31], v[52:55], v[156:159]
    ds_write_b64 v17, v[148:149] offset:3584
    v_mul_f32 v153, s74, v153
    v_mfma_f32_16x16x32_bf16 v[160:163], v[192:195], a[0:3], v[160:163]
    ds_read_b128 a[164:167], v6 offset:64
    ds_read_b128 a[168:171], v6 offset:128
    v_mfma_f32_16x16x32_bf16 v[160:163], v[208:211], a[20:23], v[160:163]
    ds_read_b128 a[172:175], v6 offset:192
    ds_read_b128 a[176:179], v6 offset:512
    v_mfma_f32_16x16x32_bf16 v[160:163], a[200:203], a[40:43], v[160:163]
    ds_read_b128 a[180:183], v6 offset:576
    ds_read_b128 a[184:187], v6 offset:640
    v_mfma_f32_16x16x32_bf16 v[160:163], v[32:35], v[52:55], v[160:163]
    ds_read_b128 a[188:191], v6 offset:704
    v_mul_f32 v154, s74, v154
    v_mfma_f32_16x16x32_bf16 v[164:167], v[196:199], a[0:3], v[164:167]
    buffer_load_dwordx4 v3, s[8:11], s80 offen offset:1056 nt lds
    v_mul_f32 v155, s74, v155
    v_mfma_f32_16x16x32_bf16 v[164:167], v[212:215], a[20:23], v[164:167]
    v_cvt_pk_bf16_f32 v152, v152, v153
    v_cvt_pk_bf16_f32 v153, v154, v155
    v_mul_f32 v156, s74, v156
    v_mfma_f32_16x16x32_bf16 v[164:167], a[204:207], a[40:43], v[164:167]
    s_waitcnt vmcnt(18) lgkmcnt(0)
    s_barrier
    v_mul_f32 v157, s74, v157
    v_mfma_f32_16x16x32_bf16 v[164:167], v[36:39], v[52:55], v[164:167]
    buffer_load_dwordx4 v4, s[8:11], s80 offen offset:2112 nt lds
    v_mul_f32 v158, s74, v158
    s_waitcnt lgkmcnt(15)
    v_mfma_f32_16x16x32_bf16 v[208:211], v[56:59], a[80:83], -4.0
    ds_read_b128 a[112:115], v23
    v_mul_f32 v159, s74, v159
    v_mfma_f32_16x16x32_bf16 v[208:211], v[60:63], a[84:87], v[208:211]
    ds_read_b128 a[116:119], v23 offset:1024
    v_cvt_pk_bf16_f32 v156, v156, v157
    v_mfma_f32_16x16x32_bf16 v[208:211], v[64:67], a[88:91], v[208:211]
    buffer_load_dwordx4 v5, s[8:11], s80 offen offset:3168 nt lds
    s_add_u32 m0, s40, 0x1ce00
    v_mfma_f32_16x16x32_bf16 v[208:211], v[68:71], a[92:95], v[208:211]
    s_mov_b32 s80, 0xc000
    v_cvt_pk_bf16_f32 v157, v158, v159
    v_mul_f32 v160, s74, v160
    s_waitcnt lgkmcnt(15)
    v_mfma_f32_16x16x32_bf16 v[212:215], v[56:59], a[96:99], -4.0
    ds_read_b128 a[120:123], v23 offset:6144
    v_mul_f32 v161, s74, v161
    v_mfma_f32_16x16x32_bf16 v[212:215], v[60:63], a[100:103], v[212:215]
    buffer_load_dwordx4 v2, s[12:15], s80 offen nt lds
    v_mul_f32 v162, s74, v162
    v_mfma_f32_16x16x32_bf16 v[212:215], v[64:67], a[104:107], v[212:215]
    ds_read_b128 a[124:127], v23 offset:7168
    ds_read_b64_tr_b16 v[104:105], v8 offset:16896
    v_mfma_f32_16x16x32_bf16 v[212:215], v[68:71], a[108:111], v[212:215]
    ds_write_b64 v17, v[152:153] offset:4096
    v_mul_f32 v163, s74, v163
    s_waitcnt lgkmcnt(6)
    v_mfma_f32_16x16x32_bf16 v[168:171], a[160:163], a[80:83], v[208:211]
    ds_read_b64_tr_b16 v[106:107], v8 offset:17408
    ds_read_b64_tr_b16 v[108:109], v8 offset:16928
    v_mfma_f32_16x16x32_bf16 v[168:171], a[164:167], a[84:87], v[168:171]
    buffer_load_dwordx4 v3, s[12:15], s80 offen offset:1056 nt lds
    v_cvt_pk_bf16_f32 v160, v160, v161
    v_mfma_f32_16x16x32_bf16 v[168:171], a[168:171], a[88:91], v[168:171]
    ds_write_b64 v17, v[156:157] offset:4608
    v_cvt_pk_bf16_f32 v161, v162, v163
    v_mfma_f32_16x16x32_bf16 v[168:171], a[172:175], a[92:95], v[168:171]
    ds_read_b64_tr_b16 v[110:111], v8 offset:17440
    ds_read_b64_tr_b16 v[112:113], v8 offset:16960
    v_mfma_f32_16x16x32_bf16 v[172:175], a[188:191], a[92:95], v[208:211]
    ds_read_b64_tr_b16 v[114:115], v8 offset:17472
    ds_read_b64_tr_b16 v[116:117], v8 offset:16992
    v_mfma_f32_16x16x32_bf16 v[172:175], a[184:187], a[88:91], v[172:175]
    v_exp_f32 v168, v168
    v_mul_f32 v164, s74, v164
    v_mfma_f32_16x16x32_bf16 v[172:175], a[180:183], a[84:87], v[172:175]
    buffer_load_dwordx4 v4, s[12:15], s80 offen offset:2112 nt lds
    v_mul_f32 v165, s74, v165
    v_mfma_f32_16x16x32_bf16 v[172:175], a[176:179], a[80:83], v[172:175]
    v_exp_f32 v169, v169
    v_mul_f32 v166, s74, v166
    s_waitcnt lgkmcnt(9)
    v_mfma_f32_16x16x32_bf16 v[216:219], v[56:59], a[112:115], -4.0
    v_cvt_pk_bf16_f32 v200, v168, v169
    ds_write_b64 v17, v[160:161] offset:5120
    v_mfma_f32_16x16x32_bf16 v[216:219], v[60:63], a[116:119], v[216:219]
    v_exp_f32 v170, v170
    v_mul_f32 v167, s74, v167
    v_mfma_f32_16x16x32_bf16 v[216:219], v[64:67], a[120:123], v[216:219]
    ds_read_b64_tr_b16 v[118:119], v8 offset:17504
    ds_read_b64_tr_b16 v[120:121], v10 offset:16896
    v_mfma_f32_16x16x32_bf16 v[216:219], v[68:71], a[124:127], v[216:219]
    v_exp_f32 v171, v171
    v_cvt_pk_bf16_f32 v164, v164, v165
    v_mfma_f32_16x16x32_bf16 v[176:179], a[160:163], a[96:99], v[212:215]
    v_cvt_pk_bf16_f32 v201, v170, v171
    buffer_load_dwordx4 v5, s[12:15], s80 offen offset:3168 nt lds
    v_mfma_f32_16x16x32_bf16 v[176:179], a[164:167], a[100:103], v[176:179]
    v_exp_f32 v172, v172
    v_cvt_pk_bf16_f32 v165, v166, v167
    v_mfma_f32_16x16x32_bf16 v[176:179], a[168:171], a[104:107], v[176:179]
    s_add_u32 m0, s40, 0
    s_mov_b32 s80, 0x10000
    v_mfma_f32_16x16x32_bf16 v[176:179], a[172:175], a[108:111], v[176:179]
    v_exp_f32 v173, v173
    v_mfma_f32_16x16x32_bf16 v[180:183], a[188:191], a[108:111], v[212:215]
    v_cvt_pk_bf16_f32 v202, v172, v173
    buffer_load_dwordx4 v2, s[8:11], s80 offen nt lds
    v_mfma_f32_16x16x32_bf16 v[180:183], a[184:187], a[104:107], v[180:183]
    v_exp_f32 v174, v174
    v_mfma_f32_16x16x32_bf16 v[180:183], a[180:183], a[100:103], v[180:183]
    ds_read_b64_tr_b16 v[122:123], v10 offset:17408
    ds_read_b64_tr_b16 v[124:125], v10 offset:16928
    v_mfma_f32_16x16x32_bf16 v[180:183], a[176:179], a[96:99], v[180:183]
    v_exp_f32 v175, v175
    v_mfma_f32_16x16x32_bf16 v[184:187], a[160:163], a[112:115], v[216:219]
    v_cvt_pk_bf16_f32 v203, v174, v175
    ds_write_b64 v17, v[164:165] offset:5632
    v_mfma_f32_16x16x32_bf16 v[184:187], a[164:167], a[116:119], v[184:187]
    ds_read_b64_tr_b16 v[126:127], v10 offset:17440
    ds_read_b64_tr_b16 v[128:129], v10 offset:16960
    v_mfma_f32_16x16x32_bf16 v[184:187], a[168:171], a[120:123], v[184:187]
    ds_read_b64_tr_b16 v[130:131], v10 offset:17472
    ds_read_b64_tr_b16 v[132:133], v10 offset:16992
    v_mfma_f32_16x16x32_bf16 v[184:187], a[172:175], a[124:127], v[184:187]
    ds_read_b64_tr_b16 v[134:135], v10 offset:17504
    ds_read_b128 a[128:131], v23 offset:2048
    v_mfma_f32_16x16x32_bf16 v[188:191], a[188:191], a[124:127], v[216:219]
    buffer_load_dwordx4 v3, s[8:11], s80 offen offset:1056 nt lds
    v_mfma_f32_16x16x32_bf16 v[188:191], a[184:187], a[120:123], v[188:191]
    v_exp_f32 v176, v176
    v_mfma_f32_16x16x32_bf16 v[188:191], a[180:183], a[116:119], v[188:191]
    s_waitcnt vmcnt(18) lgkmcnt(1)
    s_barrier
    v_mfma_f32_16x16x32_bf16 v[188:191], a[176:179], a[112:115], v[188:191]
    v_exp_f32 v177, v177
    s_waitcnt lgkmcnt(1)
    v_mfma_f32_16x16x32_bf16 v[24:27], v[200:203], v[104:107], 0
    v_cvt_pk_bf16_f32 v204, v176, v177
    buffer_load_dwordx4 v4, s[8:11], s80 offen offset:2112 nt lds
    v_mfma_f32_16x16x32_bf16 v[28:31], v[200:203], v[108:111], 0
    v_exp_f32 v178, v178
    v_mfma_f32_16x16x32_bf16 v[32:35], v[200:203], v[112:115], 0
    ds_read_b128 a[132:135], v23 offset:3072
    ds_read_b128 a[136:139], v23 offset:8192
    v_mfma_f32_16x16x32_bf16 v[36:39], v[200:203], v[116:119], 0
    v_exp_f32 v179, v179
    v_mfma_f32_16x16x32_bf16 a[0:3], v[200:203], v[120:123], 0
    v_cvt_pk_bf16_f32 v205, v178, v179
    ds_read_b128 a[140:143], v23 offset:9216
    v_mfma_f32_16x16x32_bf16 a[4:7], v[200:203], v[124:127], 0
    v_exp_f32 v180, v180
    v_mfma_f32_16x16x32_bf16 a[8:11], v[200:203], v[128:131], 0
    buffer_load_dwordx4 v5, s[8:11], s80 offen offset:3168 nt lds
    s_add_u32 m0, s40, 0x4200
    v_mfma_f32_16x16x32_bf16 a[12:15], v[200:203], v[132:135], 0
    v_exp_f32 v181, v181
    s_mov_b32 s80, 0x10000
    s_waitcnt lgkmcnt(0)
    v_mfma_f32_16x16x32_bf16 v[220:223], v[56:59], a[128:131], -4.0
    v_cvt_pk_bf16_f32 v206, v180, v181
    ds_read_b128 a[144:147], v23 offset:4096
    v_mfma_f32_16x16x32_bf16 v[220:223], v[60:63], a[132:135], v[220:223]
    v_exp_f32 v182, v182
    v_mfma_f32_16x16x32_bf16 v[220:223], v[64:67], a[136:139], v[220:223]
    buffer_load_dwordx4 v2, s[12:15], s80 offen nt lds
    v_mfma_f32_16x16x32_bf16 v[220:223], v[68:71], a[140:143], v[220:223]
    v_exp_f32 v183, v183
    v_mfma_f32_16x16x32_bf16 v[192:195], a[160:163], a[128:131], v[220:223]
    v_cvt_pk_bf16_f32 v207, v182, v183
    ds_read_b128 a[148:151], v23 offset:5120
    v_mfma_f32_16x16x32_bf16 v[192:195], a[164:167], a[132:135], v[192:195]
    buffer_load_dwordx4 v3, s[12:15], s80 offen offset:1056 nt lds
    v_mfma_f32_16x16x32_bf16 v[192:195], a[168:171], a[136:139], v[192:195]
    v_exp_f32 v184, v184
    v_mfma_f32_16x16x32_bf16 v[192:195], a[172:175], a[140:143], v[192:195]
    ds_read_b128 a[152:155], v23 offset:10240
    ds_read_b128 a[156:159], v23 offset:11264
    v_smfmac_f32_16x16x64_bf16 v[240:243], a[224:227], v[200:207], v16
    v_exp_f32 v185, v185
    v_mfma_f32_16x16x32_bf16 v[196:199], a[188:191], a[140:143], v[220:223]
    ds_read_b128 a[192:195], v6 offset:33792
    ds_read_b128 a[196:199], v6 offset:33856
    v_mfma_f32_16x16x32_bf16 v[196:199], a[184:187], a[136:139], v[196:199]
    buffer_load_dwordx4 v4, s[12:15], s80 offen offset:2112 nt lds
    v_cvt_pk_bf16_f32 v200, v184, v185
    v_mfma_f32_16x16x32_bf16 v[196:199], a[180:183], a[132:135], v[196:199]
    v_exp_f32 v186, v186
    v_mfma_f32_16x16x32_bf16 v[196:199], a[176:179], a[128:131], v[196:199]
    ds_read_b128 a[200:203], v6 offset:33920
    ds_read_b128 a[204:207], v6 offset:33984
    v_mfma_f32_16x16x32_bf16 v[40:43], v[204:207], v[104:107], 0
    v_exp_f32 v187, v187
    v_mfma_f32_16x16x32_bf16 v[44:47], v[204:207], v[108:111], 0
    ds_read_b128 a[208:211], v6 offset:34304
    ds_read_b128 a[212:215], v6 offset:34368
    v_mfma_f32_16x16x32_bf16 v[48:51], v[204:207], v[112:115], 0
    v_exp_f32 v188, v188
    v_cvt_pk_bf16_f32 v201, v186, v187
    v_mfma_f32_16x16x32_bf16 v[52:55], v[204:207], v[116:119], 0
    buffer_load_dwordx4 v5, s[12:15], s80 offen offset:3168 nt lds
    v_mfma_f32_16x16x32_bf16 a[16:19], v[204:207], v[120:123], 0
    v_exp_f32 v189, v189
    v_mfma_f32_16x16x32_bf16 a[20:23], v[204:207], v[124:127], 0
    ds_read_b128 a[216:219], v6 offset:34432
    ds_read_b64_tr_b16 v[136:137], v8 offset:50688
    v_mfma_f32_16x16x32_bf16 a[24:27], v[204:207], v[128:131], 0
    v_exp_f32 v190, v190
    v_cvt_pk_bf16_f32 v202, v188, v189
    v_mfma_f32_16x16x32_bf16 a[28:31], v[204:207], v[132:135], 0
    s_add_u32 m0, s40, 0x8400
    ds_read_b128 a[220:223], v6 offset:34496
    s_waitcnt lgkmcnt(9)
    v_mfma_f32_16x16x32_bf16 v[224:227], v[56:59], a[144:147], -4.0
    v_exp_f32 v191, v191
    v_mfma_f32_16x16x32_bf16 v[224:227], v[60:63], a[148:151], v[224:227]
    ds_read_b64_tr_b16 v[138:139], v8 offset:51200
    ds_read_b64_tr_b16 v[140:141], v8 offset:50720
    v_mfma_f32_16x16x32_bf16 v[224:227], v[64:67], a[152:155], v[224:227]
    v_exp_f32 v192, v192
    v_cvt_pk_bf16_f32 v203, v190, v191
    v_mfma_f32_16x16x32_bf16 v[224:227], v[68:71], a[156:159], v[224:227]
    ds_read_b64_tr_b16 v[142:143], v8 offset:51232
    ds_read_b64_tr_b16 v[144:145], v8 offset:50752
    v_mfma_f32_16x16x32_bf16 v[168:171], a[160:163], a[144:147], v[224:227]
    v_exp_f32 v193, v193
    v_mfma_f32_16x16x32_bf16 v[168:171], a[164:167], a[148:151], v[168:171]
    ds_read_b64_tr_b16 v[146:147], v8 offset:51264
    ds_read_b64_tr_b16 v[148:149], v8 offset:50784
    v_mfma_f32_16x16x32_bf16 v[168:171], a[168:171], a[152:155], v[168:171]
    v_exp_f32 v194, v194
    v_cvt_pk_bf16_f32 v204, v192, v193
    v_mfma_f32_16x16x32_bf16 v[168:171], a[172:175], a[156:159], v[168:171]
    ds_read_b64_tr_b16 v[150:151], v8 offset:51296
    ds_read_b64_tr_b16 v[152:153], v10 offset:50688
    v_mfma_f32_16x16x32_bf16 v[172:175], a[188:191], a[156:159], v[224:227]
    v_exp_f32 v195, v195
    v_mfma_f32_16x16x32_bf16 v[172:175], a[184:187], a[152:155], v[172:175]
    ds_read_b64_tr_b16 v[154:155], v10 offset:51200
    ds_read_b64_tr_b16 v[156:157], v10 offset:50720
    v_mfma_f32_16x16x32_bf16 v[172:175], a[180:183], a[148:151], v[172:175]
    v_exp_f32 v196, v196
    v_cvt_pk_bf16_f32 v205, v194, v195
    v_mfma_f32_16x16x32_bf16 v[172:175], a[176:179], a[144:147], v[172:175]
    ds_read_b64_tr_b16 v[158:159], v10 offset:51232
    ds_read_b64_tr_b16 v[160:161], v10 offset:50752
    v_mfma_f32_16x16x32_bf16 v[56:59], v[200:203], v[104:107], 0
    v_exp_f32 v197, v197
    v_mfma_f32_16x16x32_bf16 v[60:63], v[200:203], v[108:111], 0
    ds_read_b64_tr_b16 v[162:163], v10 offset:51264
    ds_read_b64_tr_b16 v[164:165], v10 offset:50784
    v_mfma_f32_16x16x32_bf16 v[64:67], v[200:203], v[112:115], 0
    v_exp_f32 v198, v198
    v_cvt_pk_bf16_f32 v206, v196, v197
    v_mfma_f32_16x16x32_bf16 v[68:71], v[200:203], v[116:119], 0
    ds_read_b64_tr_b16 v[166:167], v10 offset:51296
    v_mfma_f32_16x16x32_bf16 a[32:35], v[200:203], v[120:123], 0
    v_exp_f32 v199, v199
    v_mfma_f32_16x16x32_bf16 a[36:39], v[200:203], v[124:127], 0
    v_cvt_pk_bf16_f32 v207, v198, v199
    v_mfma_f32_16x16x32_bf16 a[40:43], v[200:203], v[128:131], 0
    s_waitcnt lgkmcnt(15)
    v_mfma_f32_16x16x32_bf16 a[44:47], v[200:203], v[132:135], 0
    s_branch L_blk1
    .p2align 6
L_loop:
    v_mfma_f32_16x16x32_bf16 v[168:171], a[160:163], a[80:83], v[208:211]
    v_exp_f32 v192, v192
    v_mfma_f32_16x16x32_bf16 v[168:171], a[164:167], a[84:87], v[168:171]
    s_waitcnt vmcnt(16) lgkmcnt(0)
    s_barrier
L_loop_mid:
    v_mfma_f32_16x16x32_bf16 v[168:171], a[168:171], a[88:91], v[168:171]
    v_exp_f32 v193, v193
    v_mfma_f32_16x16x32_bf16 v[168:171], a[172:175], a[92:95], v[168:171]
    ds_read_b128 a[192:195], v6 offset:33792
    v_cvt_pk_bf16_f32 v204, v192, v193
    v_mfma_f32_16x16x32_bf16 v[172:175], a[188:191], a[92:95], v[208:211]
    v_exp_f32 v194, v194
    v_mfma_f32_16x16x32_bf16 v[172:175], a[184:187], a[88:91], v[172:175]
    buffer_load_dwordx4 v2, s[8:11], s38 offen nt lds
    v_mfma_f32_16x16x32_bf16 v[172:175], a[180:183], a[84:87], v[172:175]
    v_exp_f32 v195, v195
    v_mfma_f32_16x16x32_bf16 v[172:175], a[176:179], a[80:83], v[172:175]
    ds_read_b128 a[196:199], v6 offset:33856
    v_cvt_pk_bf16_f32 v205, v194, v195
    v_mfma_f32_16x16x32_bf16 v[72:75], v[200:203], v[136:139], v[72:75]
    v_exp_f32 v196, v196
    v_mfma_f32_16x16x32_bf16 v[76:79], v[200:203], v[140:143], v[76:79]
    ds_read_b128 a[200:203], v6 offset:33920
    ds_read_b128 a[204:207], v6 offset:33984
    v_mfma_f32_16x16x32_bf16 v[80:83], v[200:203], v[144:147], v[80:83]
    v_exp_f32 v197, v197
    v_mfma_f32_16x16x32_bf16 v[84:87], v[200:203], v[148:151], v[84:87]
    ds_read_b128 a[208:211], v6 offset:34304
    v_cvt_pk_bf16_f32 v206, v196, v197
    v_mfma_f32_16x16x32_bf16 a[48:51], v[200:203], v[152:155], a[48:51]
    v_exp_f32 v198, v198
    v_mfma_f32_16x16x32_bf16 a[52:55], v[200:203], v[156:159], a[52:55]
    buffer_load_dwordx4 v3, s[8:11], s38 offen offset:1056 nt lds
    v_mfma_f32_16x16x32_bf16 a[56:59], v[200:203], v[160:163], a[56:59]
    v_exp_f32 v199, v199
    v_mfma_f32_16x16x32_bf16 a[60:63], v[200:203], v[164:167], a[60:63]
    ds_read_b128 a[212:215], v6 offset:34368
    v_cvt_pk_bf16_f32 v207, v198, v199
    v_mfma_f32_16x16x32_bf16 v[176:179], a[160:163], a[96:99], v[212:215]
    v_exp_f32 v168, v168
    v_mfma_f32_16x16x32_bf16 v[176:179], a[164:167], a[100:103], v[176:179]
    v_mfma_f32_16x16x32_bf16 v[176:179], a[168:171], a[104:107], v[176:179]
    v_exp_f32 v169, v169
    v_mfma_f32_16x16x32_bf16 v[176:179], a[172:175], a[108:111], v[176:179]
    ds_read_b128 a[216:219], v6 offset:34432
    v_smfmac_f32_16x16x64_bf16 v[240:243], a[248:251], v[200:207], v16
    v_cvt_pk_bf16_f32 v200, v168, v169
    v_mfma_f32_16x16x32_bf16 v[180:183], a[188:191], a[108:111], v[212:215]
    v_exp_f32 v170, v170
    v_mfma_f32_16x16x32_bf16 v[180:183], a[184:187], a[104:107], v[180:183]
    v_mfma_f32_16x16x32_bf16 v[180:183], a[180:183], a[100:103], v[180:183]
    v_exp_f32 v171, v171
    v_mfma_f32_16x16x32_bf16 v[180:183], a[176:179], a[96:99], v[180:183]
    ds_read_b128 a[220:223], v6 offset:34496
    v_cvt_pk_bf16_f32 v201, v170, v171
    v_mfma_f32_16x16x32_bf16 v[88:91], v[204:207], v[136:139], v[88:91]
    v_exp_f32 v172, v172
    v_mfma_f32_16x16x32_bf16 v[92:95], v[204:207], v[140:143], v[92:95]
    buffer_load_dwordx4 v4, s[8:11], s38 offen offset:2112 nt lds
    v_mfma_f32_16x16x32_bf16 v[96:99], v[204:207], v[144:147], v[96:99]
    v_exp_f32 v173, v173
    v_mfma_f32_16x16x32_bf16 v[100:103], v[204:207], v[148:151], v[100:103]
    ds_read_b64_tr_b16 v[136:137], v8 offset:50688
    v_cvt_pk_bf16_f32 v202, v172, v173
    v_mfma_f32_16x16x32_bf16 a[64:67], v[204:207], v[152:155], a[64:67]
    v_exp_f32 v174, v174
    v_mfma_f32_16x16x32_bf16 a[68:71], v[204:207], v[156:159], a[68:71]
    ds_read_b64_tr_b16 v[138:139], v8 offset:51200
    v_mfma_f32_16x16x32_bf16 a[72:75], v[204:207], v[160:163], a[72:75]
    v_exp_f32 v175, v175
    v_mfma_f32_16x16x32_bf16 a[76:79], v[204:207], v[164:167], a[76:79]
    ds_read_b64_tr_b16 v[140:141], v8 offset:50720
    v_cvt_pk_bf16_f32 v203, v174, v175
    v_mfma_f32_16x16x32_bf16 v[184:187], a[160:163], a[112:115], v[216:219]
    v_exp_f32 v176, v176
    v_mfma_f32_16x16x32_bf16 v[184:187], a[164:167], a[116:119], v[184:187]
    buffer_load_dwordx4 v5, s[8:11], s38 offen offset:3168 nt lds
    v_mfma_f32_16x16x32_bf16 v[184:187], a[168:171], a[120:123], v[184:187]
    v_exp_f32 v177, v177
    v_mfma_f32_16x16x32_bf16 v[184:187], a[172:175], a[124:127], v[184:187]
    ds_read_b64_tr_b16 v[142:143], v8 offset:51232
    v_cvt_pk_bf16_f32 v204, v176, v177
    v_mfma_f32_16x16x32_bf16 v[188:191], a[188:191], a[124:127], v[216:219]
    v_exp_f32 v178, v178
    v_mfma_f32_16x16x32_bf16 v[188:191], a[184:187], a[120:123], v[188:191]
    s_add_u32 m0, s40, 0x4200
    v_mfma_f32_16x16x32_bf16 v[188:191], a[180:183], a[116:119], v[188:191]
    v_exp_f32 v179, v179
    v_mfma_f32_16x16x32_bf16 v[188:191], a[176:179], a[112:115], v[188:191]
    ds_read_b64_tr_b16 v[144:145], v8 offset:50752
    v_cvt_pk_bf16_f32 v205, v178, v179
    v_mfma_f32_16x16x32_bf16 v[24:27], v[200:203], v[104:107], v[24:27]
    v_exp_f32 v180, v180
    v_mfma_f32_16x16x32_bf16 v[28:31], v[200:203], v[108:111], v[28:31]
    ds_read_b64_tr_b16 v[146:147], v8 offset:51264
    v_mfma_f32_16x16x32_bf16 v[32:35], v[200:203], v[112:115], v[32:35]
    v_exp_f32 v181, v181
    v_mfma_f32_16x16x32_bf16 v[36:39], v[200:203], v[116:119], v[36:39]
    ds_read_b64_tr_b16 v[148:149], v8 offset:50784
    v_cvt_pk_bf16_f32 v206, v180, v181
    v_mfma_f32_16x16x32_bf16 a[0:3], v[200:203], v[120:123], a[0:3]
    v_exp_f32 v182, v182
    v_mfma_f32_16x16x32_bf16 a[4:7], v[200:203], v[124:127], a[4:7]
    buffer_load_dwordx4 v2, s[12:15], s38 offen nt lds
    v_mfma_f32_16x16x32_bf16 a[8:11], v[200:203], v[128:131], a[8:11]
    v_exp_f32 v183, v183
    v_mfma_f32_16x16x32_bf16 a[12:15], v[200:203], v[132:135], a[12:15]
    ds_read_b64_tr_b16 v[150:151], v8 offset:51296
    v_cvt_pk_bf16_f32 v207, v182, v183
    v_mfma_f32_16x16x32_bf16 v[192:195], a[160:163], a[128:131], v[220:223]
    v_exp_f32 v184, v184
    v_mfma_f32_16x16x32_bf16 v[192:195], a[164:167], a[132:135], v[192:195]
    s_waitcnt lgkmcnt(8)
    v_mfma_f32_16x16x32_bf16 v[192:195], a[168:171], a[136:139], v[192:195]
    v_exp_f32 v185, v185
    v_mfma_f32_16x16x32_bf16 v[192:195], a[172:175], a[140:143], v[192:195]
    ds_read_b64_tr_b16 v[152:153], v10 offset:50688
    v_smfmac_f32_16x16x64_bf16 v[240:243], a[224:227], v[200:207], v16
    v_cvt_pk_bf16_f32 v200, v184, v185
    v_mfma_f32_16x16x32_bf16 v[196:199], a[188:191], a[140:143], v[220:223]
    v_exp_f32 v186, v186
    v_mfma_f32_16x16x32_bf16 v[196:199], a[184:187], a[136:139], v[196:199]
    buffer_load_dwordx4 v3, s[12:15], s38 offen offset:1056 nt lds
    v_mfma_f32_16x16x32_bf16 v[196:199], a[180:183], a[132:135], v[196:199]
    v_exp_f32 v187, v187
    v_mfma_f32_16x16x32_bf16 v[196:199], a[176:179], a[128:131], v[196:199]
    ds_read_b64_tr_b16 v[154:155], v10 offset:51200
    v_cvt_pk_bf16_f32 v201, v186, v187
    v_mfma_f32_16x16x32_bf16 v[40:43], v[204:207], v[104:107], v[40:43]
    v_exp_f32 v188, v188
    v_mfma_f32_16x16x32_bf16 v[44:47], v[204:207], v[108:111], v[44:47]
    ds_read_b64_tr_b16 v[156:157], v10 offset:50720
    v_mfma_f32_16x16x32_bf16 v[48:51], v[204:207], v[112:115], v[48:51]
    v_exp_f32 v189, v189
    v_mfma_f32_16x16x32_bf16 v[52:55], v[204:207], v[116:119], v[52:55]
    ds_read_b64_tr_b16 v[158:159], v10 offset:51232
    v_cvt_pk_bf16_f32 v202, v188, v189
    v_mfma_f32_16x16x32_bf16 a[16:19], v[204:207], v[120:123], a[16:19]
    v_exp_f32 v190, v190
    v_mfma_f32_16x16x32_bf16 a[20:23], v[204:207], v[124:127], a[20:23]
    v_mfma_f32_16x16x32_bf16 a[24:27], v[204:207], v[128:131], a[24:27]
    v_exp_f32 v191, v191
    v_mfma_f32_16x16x32_bf16 a[28:31], v[204:207], v[132:135], a[28:31]
    ds_read_b64_tr_b16 v[160:161], v10 offset:50752
    v_cvt_pk_bf16_f32 v203, v190, v191
    v_mfma_f32_16x16x32_bf16 v[168:171], a[160:163], a[144:147], v[224:227]
    v_exp_f32 v192, v192
    v_mfma_f32_16x16x32_bf16 v[168:171], a[164:167], a[148:151], v[168:171]
    buffer_load_dwordx4 v4, s[12:15], s38 offen offset:2112 nt lds
    v_mfma_f32_16x16x32_bf16 v[168:171], a[168:171], a[152:155], v[168:171]
    v_exp_f32 v193, v193
    v_mfma_f32_16x16x32_bf16 v[168:171], a[172:175], a[156:159], v[168:171]
    ds_read_b64_tr_b16 v[162:163], v10 offset:51264
    v_cvt_pk_bf16_f32 v204, v192, v193
    v_mfma_f32_16x16x32_bf16 v[172:175], a[188:191], a[156:159], v[224:227]
    v_exp_f32 v194, v194
    v_mfma_f32_16x16x32_bf16 v[172:175], a[184:187], a[152:155], v[172:175]
    ds_read_b64_tr_b16 v[164:165], v10 offset:50784
    v_mfma_f32_16x16x32_bf16 v[172:175], a[180:183], a[148:151], v[172:175]
    v_exp_f32 v195, v195
    v_mfma_f32_16x16x32_bf16 v[172:175], a[176:179], a[144:147], v[172:175]
    ds_read_b64_tr_b16 v[166:167], v10 offset:51296
    v_cvt_pk_bf16_f32 v205, v194, v195
    v_mfma_f32_16x16x32_bf16 v[56:59], v[200:203], v[104:107], v[56:59]
    v_exp_f32 v196, v196
    v_mfma_f32_16x16x32_bf16 v[60:63], v[200:203], v[108:111], v[60:63]
    buffer_load_dwordx4 v5, s[12:15], s38 offen offset:3168 nt lds
    v_mfma_f32_16x16x32_bf16 v[64:67], v[200:203], v[112:115], v[64:67]
    v_exp_f32 v197, v197
    v_mfma_f32_16x16x32_bf16 v[68:71], v[200:203], v[116:119], v[68:71]
    v_cvt_pk_bf16_f32 v206, v196, v197
    v_mfma_f32_16x16x32_bf16 a[32:35], v[200:203], v[120:123], a[32:35]
    v_exp_f32 v198, v198
    v_mfma_f32_16x16x32_bf16 a[36:39], v[200:203], v[124:127], a[36:39]
    s_add_u32 s38, s38, s39
    s_add_u32 m0, s40, 0x8400
    v_mfma_f32_16x16x32_bf16 a[40:43], v[200:203], v[128:131], a[40:43]
    v_exp_f32 v199, v199
    v_mfma_f32_16x16x32_bf16 a[44:47], v[200:203], v[132:135], a[44:47]
    v_cvt_pk_bf16_f32 v207, v198, v199
L_blk1:
    v_mfma_f32_16x16x32_bf16 v[176:179], a[192:195], a[80:83], v[208:211]
    v_exp_f32 v168, v168
    v_mfma_f32_16x16x32_bf16 v[176:179], a[196:199], a[84:87], v[176:179]
    s_waitcnt vmcnt(16) lgkmcnt(0)
    s_barrier
    v_mfma_f32_16x16x32_bf16 v[176:179], a[200:203], a[88:91], v[176:179]
    v_exp_f32 v169, v169
    v_mfma_f32_16x16x32_bf16 v[176:179], a[204:207], a[92:95], v[176:179]
    ds_read_b128 a[160:163], v7
    v_smfmac_f32_16x16x64_bf16 v[240:243], a[228:231], v[200:207], v16
    v_cvt_pk_bf16_f32 v200, v168, v169
    v_mfma_f32_16x16x32_bf16 v[180:183], a[220:223], a[92:95], v[208:211]
    v_exp_f32 v170, v170
    v_mfma_f32_16x16x32_bf16 v[180:183], a[216:219], a[88:91], v[180:183]
    buffer_load_dwordx4 v2, s[8:11], s38 offen nt lds
    v_mfma_f32_16x16x32_bf16 v[180:183], a[212:215], a[84:87], v[180:183]
    v_exp_f32 v171, v171
    v_mfma_f32_16x16x32_bf16 v[180:183], a[208:211], a[80:83], v[180:183]
    ds_read_b128 a[164:167], v7 offset:64
    v_cvt_pk_bf16_f32 v201, v170, v171
    v_mfma_f32_16x16x32_bf16 v[72:75], v[204:207], v[104:107], v[72:75]
    v_exp_f32 v172, v172
    v_mfma_f32_16x16x32_bf16 v[76:79], v[204:207], v[108:111], v[76:79]
    ds_read_b128 a[168:171], v7 offset:128
    ds_read_b128 a[172:175], v7 offset:192
    v_mfma_f32_16x16x32_bf16 v[80:83], v[204:207], v[112:115], v[80:83]
    v_exp_f32 v173, v173
    v_mfma_f32_16x16x32_bf16 v[84:87], v[204:207], v[116:119], v[84:87]
    ds_read_b128 a[176:179], v7 offset:512
    v_cvt_pk_bf16_f32 v202, v172, v173
    v_mfma_f32_16x16x32_bf16 a[48:51], v[204:207], v[120:123], a[48:51]
    v_exp_f32 v174, v174
    v_mfma_f32_16x16x32_bf16 a[52:55], v[204:207], v[124:127], a[52:55]
    buffer_load_dwordx4 v3, s[8:11], s38 offen offset:1056 nt lds
    v_mfma_f32_16x16x32_bf16 a[56:59], v[204:207], v[128:131], a[56:59]
    v_exp_f32 v175, v175
    v_mfma_f32_16x16x32_bf16 a[60:63], v[204:207], v[132:135], a[60:63]
    ds_read_b128 a[180:183], v7 offset:576
    v_cvt_pk_bf16_f32 v203, v174, v175
    v_mfma_f32_16x16x32_bf16 v[184:187], a[192:195], a[96:99], v[212:215]
    v_exp_f32 v176, v176
    v_mfma_f32_16x16x32_bf16 v[184:187], a[196:199], a[100:103], v[184:187]
    v_mfma_f32_16x16x32_bf16 v[184:187], a[200:203], a[104:107], v[184:187]
    v_exp_f32 v177, v177
    v_mfma_f32_16x16x32_bf16 v[184:187], a[204:207], a[108:111], v[184:187]
    ds_read_b128 a[184:187], v7 offset:640
    v_cvt_pk_bf16_f32 v204, v176, v177
    v_mfma_f32_16x16x32_bf16 v[188:191], a[220:223], a[108:111], v[212:215]
    v_exp_f32 v178, v178
    v_mfma_f32_16x16x32_bf16 v[188:191], a[216:219], a[104:107], v[188:191]
    buffer_load_dwordx2 v[238:239], v231, s[56:59], s3 offen
    v_mfma_f32_16x16x32_bf16 v[188:191], a[212:215], a[100:103], v[188:191]
    v_exp_f32 v179, v179
    v_mfma_f32_16x16x32_bf16 v[188:191], a[208:211], a[96:99], v[188:191]
    ds_read_b128 a[188:191], v7 offset:704
    v_cvt_pk_bf16_f32 v205, v178, v179
    v_mfma_f32_16x16x32_bf16 v[88:91], v[200:203], v[104:107], v[88:91]
    v_exp_f32 v180, v180
    v_mfma_f32_16x16x32_bf16 v[92:95], v[200:203], v[108:111], v[92:95]
    buffer_load_dwordx4 v4, s[8:11], s38 offen offset:2112 nt lds
    v_mfma_f32_16x16x32_bf16 v[96:99], v[200:203], v[112:115], v[96:99]
    v_exp_f32 v181, v181
    v_mfma_f32_16x16x32_bf16 v[100:103], v[200:203], v[116:119], v[100:103]
    ds_read_b64_tr_b16 v[104:105], v9 offset:16896
    v_cvt_pk_bf16_f32 v206, v180, v181
    v_mfma_f32_16x16x32_bf16 a[64:67], v[200:203], v[120:123], a[64:67]
    v_exp_f32 v182, v182
    v_mfma_f32_16x16x32_bf16 a[68:71], v[200:203], v[124:127], a[68:71]
    ds_read_b64_tr_b16 v[106:107], v9 offset:17408
    v_mfma_f32_16x16x32_bf16 a[72:75], v[200:203], v[128:131], a[72:75]
    v_exp_f32 v183, v183
    v_mfma_f32_16x16x32_bf16 a[76:79], v[200:203], v[132:135], a[76:79]
    ds_read_b64_tr_b16 v[108:109], v9 offset:16928
    v_cvt_pk_bf16_f32 v207, v182, v183
    v_mfma_f32_16x16x32_bf16 v[192:195], a[192:195], a[112:115], v[216:219]
    v_exp_f32 v184, v184
    v_mfma_f32_16x16x32_bf16 v[192:195], a[196:199], a[116:119], v[192:195]
    buffer_load_dwordx4 v5, s[8:11], s38 offen offset:3168 nt lds
    v_mfma_f32_16x16x32_bf16 v[192:195], a[200:203], a[120:123], v[192:195]
    v_exp_f32 v185, v185
    v_mfma_f32_16x16x32_bf16 v[192:195], a[204:207], a[124:127], v[192:195]
    ds_read_b64_tr_b16 v[110:111], v9 offset:17440
    v_smfmac_f32_16x16x64_bf16 v[240:243], a[232:235], v[200:207], v16
    v_cvt_pk_bf16_f32 v200, v184, v185
    v_mfma_f32_16x16x32_bf16 v[196:199], a[220:223], a[124:127], v[216:219]
    v_exp_f32 v186, v186
    v_mfma_f32_16x16x32_bf16 v[196:199], a[216:219], a[120:123], v[196:199]
    s_add_u32 m0, s40, 0xc600
    v_mfma_f32_16x16x32_bf16 v[196:199], a[212:215], a[116:119], v[196:199]
    v_exp_f32 v187, v187
    v_mfma_f32_16x16x32_bf16 v[196:199], a[208:211], a[112:115], v[196:199]
    ds_read_b64_tr_b16 v[112:113], v9 offset:16960
    v_cvt_pk_bf16_f32 v201, v186, v187
    v_mfma_f32_16x16x32_bf16 v[24:27], v[204:207], v[136:139], v[24:27]
    v_exp_f32 v188, v188
    v_mfma_f32_16x16x32_bf16 v[28:31], v[204:207], v[140:143], v[28:31]
    ds_read_b64_tr_b16 v[114:115], v9 offset:17472
    v_mfma_f32_16x16x32_bf16 v[32:35], v[204:207], v[144:147], v[32:35]
    v_exp_f32 v189, v189
    v_mfma_f32_16x16x32_bf16 v[36:39], v[204:207], v[148:151], v[36:39]
    ds_read_b64_tr_b16 v[116:117], v9 offset:16992
    v_cvt_pk_bf16_f32 v202, v188, v189
    v_mfma_f32_16x16x32_bf16 a[0:3], v[204:207], v[152:155], a[0:3]
    v_exp_f32 v190, v190
    v_mfma_f32_16x16x32_bf16 a[4:7], v[204:207], v[156:159], a[4:7]
    buffer_load_dwordx4 v2, s[12:15], s38 offen nt lds
    v_mfma_f32_16x16x32_bf16 a[8:11], v[204:207], v[160:163], a[8:11]
    v_exp_f32 v191, v191
    v_mfma_f32_16x16x32_bf16 a[12:15], v[204:207], v[164:167], a[12:15]
    ds_read_b64_tr_b16 v[118:119], v9 offset:17504
    v_cvt_pk_bf16_f32 v203, v190, v191
    v_mfma_f32_16x16x32_bf16 v[168:171], a[192:195], a[128:131], v[220:223]
    v_exp_f32 v192, v192
    v_mfma_f32_16x16x32_bf16 v[168:171], a[196:199], a[132:135], v[168:171]
    s_waitcnt lgkmcnt(8)
    v_mfma_f32_16x16x32_bf16 v[168:171], a[200:203], a[136:139], v[168:171]
    v_exp_f32 v193, v193
    v_mfma_f32_16x16x32_bf16 v[168:171], a[204:207], a[140:143], v[168:171]
    ds_read_b64_tr_b16 v[120:121], v11 offset:16896
    v_cvt_pk_bf16_f32 v204, v192, v193
    v_mfma_f32_16x16x32_bf16 v[172:175], a[220:223], a[140:143], v[220:223]
    v_exp_f32 v194, v194
    v_mfma_f32_16x16x32_bf16 v[172:175], a[216:219], a[136:139], v[172:175]
    buffer_load_dwordx4 v3, s[12:15], s38 offen offset:1056 nt lds
    v_mfma_f32_16x16x32_bf16 v[172:175], a[212:215], a[132:135], v[172:175]
    v_exp_f32 v195, v195
    v_mfma_f32_16x16x32_bf16 v[172:175], a[208:211], a[128:131], v[172:175]
    ds_read_b64_tr_b16 v[122:123], v11 offset:17408
    v_cvt_pk_bf16_f32 v205, v194, v195
    v_mfma_f32_16x16x32_bf16 v[40:43], v[200:203], v[136:139], v[40:43]
    v_exp_f32 v196, v196
    v_mfma_f32_16x16x32_bf16 v[44:47], v[200:203], v[140:143], v[44:47]
    ds_read_b64_tr_b16 v[124:125], v11 offset:16928
    v_mfma_f32_16x16x32_bf16 v[48:51], v[200:203], v[144:147], v[48:51]
    v_exp_f32 v197, v197
    v_mfma_f32_16x16x32_bf16 v[52:55], v[200:203], v[148:151], v[52:55]
    ds_read_b64_tr_b16 v[126:127], v11 offset:17440
    v_cvt_pk_bf16_f32 v206, v196, v197
    v_mfma_f32_16x16x32_bf16 a[16:19], v[200:203], v[152:155], a[16:19]
    v_exp_f32 v198, v198
    v_mfma_f32_16x16x32_bf16 a[20:23], v[200:203], v[156:159], a[20:23]
    v_mfma_f32_16x16x32_bf16 a[24:27], v[200:203], v[160:163], a[24:27]
    v_exp_f32 v199, v199
    v_mfma_f32_16x16x32_bf16 a[28:31], v[200:203], v[164:167], a[28:31]
    ds_read_b64_tr_b16 v[128:129], v11 offset:16960
    v_cvt_pk_bf16_f32 v207, v198, v199
    v_mfma_f32_16x16x32_bf16 v[176:179], a[192:195], a[144:147], v[224:227]
    v_exp_f32 v168, v168
    v_mfma_f32_16x16x32_bf16 v[176:179], a[196:199], a[148:151], v[176:179]
    buffer_load_dwordx4 v4, s[12:15], s38 offen offset:2112 nt lds
    v_mfma_f32_16x16x32_bf16 v[176:179], a[200:203], a[152:155], v[176:179]
    v_exp_f32 v169, v169
    v_mfma_f32_16x16x32_bf16 v[176:179], a[204:207], a[156:159], v[176:179]
    ds_read_b64_tr_b16 v[130:131], v11 offset:17472
    v_smfmac_f32_16x16x64_bf16 v[240:243], a[236:239], v[200:207], v16
    v_cvt_pk_bf16_f32 v200, v168, v169
    v_mfma_f32_16x16x32_bf16 v[180:183], a[220:223], a[156:159], v[224:227]
    v_exp_f32 v170, v170
    v_mfma_f32_16x16x32_bf16 v[180:183], a[216:219], a[152:155], v[180:183]
    ds_read_b64_tr_b16 v[132:133], v11 offset:16992
    v_mfma_f32_16x16x32_bf16 v[180:183], a[212:215], a[148:151], v[180:183]
    v_exp_f32 v171, v171
    v_mfma_f32_16x16x32_bf16 v[180:183], a[208:211], a[144:147], v[180:183]
    ds_read_b64_tr_b16 v[134:135], v11 offset:17504
    v_cvt_pk_bf16_f32 v201, v170, v171
    v_mfma_f32_16x16x32_bf16 v[56:59], v[204:207], v[136:139], v[56:59]
    v_exp_f32 v172, v172
    v_mfma_f32_16x16x32_bf16 v[60:63], v[204:207], v[140:143], v[60:63]
    buffer_load_dwordx4 v5, s[12:15], s38 offen offset:3168 nt lds
    v_mfma_f32_16x16x32_bf16 v[64:67], v[204:207], v[144:147], v[64:67]
    v_exp_f32 v173, v173
    v_mfma_f32_16x16x32_bf16 v[68:71], v[204:207], v[148:151], v[68:71]
    v_cvt_pk_bf16_f32 v202, v172, v173
    v_mfma_f32_16x16x32_bf16 a[32:35], v[204:207], v[152:155], a[32:35]
    v_exp_f32 v174, v174
    v_mfma_f32_16x16x32_bf16 a[36:39], v[204:207], v[156:159], a[36:39]
    s_add_u32 s38, s38, s39
    s_add_u32 m0, s40, 0x10800
    v_mfma_f32_16x16x32_bf16 a[40:43], v[204:207], v[160:163], a[40:43]
    v_exp_f32 v175, v175
    v_mfma_f32_16x16x32_bf16 a[44:47], v[204:207], v[164:167], a[44:47]
    v_cvt_pk_bf16_f32 v203, v174, v175
    v_mfma_f32_16x16x32_bf16 v[184:187], a[160:163], a[80:83], v[208:211]
    v_exp_f32 v176, v176
    v_mfma_f32_16x16x32_bf16 v[184:187], a[164:167], a[84:87], v[184:187]
    s_waitcnt vmcnt(16) lgkmcnt(0)
    s_barrier
    v_mfma_f32_16x16x32_bf16 v[184:187], a[168:171], a[88:91], v[184:187]
    v_exp_f32 v177, v177
    v_mfma_f32_16x16x32_bf16 v[184:187], a[172:175], a[92:95], v[184:187]
    ds_read_b128 a[192:195], v7 offset:33792
    v_cvt_pk_bf16_f32 v204, v176, v177
    v_mfma_f32_16x16x32_bf16 v[188:191], a[188:191], a[92:95], v[208:211]
    v_exp_f32 v178, v178
    v_mfma_f32_16x16x32_bf16 v[188:191], a[184:187], a[88:91], v[188:191]
    buffer_load_dwordx4 v2, s[8:11], s38 offen nt lds
    v_mfma_f32_16x16x32_bf16 v[188:191], a[180:183], a[84:87], v[188:191]
    v_exp_f32 v179, v179
    v_mfma_f32_16x16x32_bf16 v[188:191], a[176:179], a[80:83], v[188:191]
    ds_read_b128 a[196:199], v7 offset:33856
    v_cvt_pk_bf16_f32 v205, v178, v179
    v_mfma_f32_16x16x32_bf16 v[72:75], v[200:203], v[136:139], v[72:75]
    v_exp_f32 v180, v180
    v_mfma_f32_16x16x32_bf16 v[76:79], v[200:203], v[140:143], v[76:79]
    ds_read_b128 a[200:203], v7 offset:33920
    ds_read_b128 a[204:207], v7 offset:33984
    v_mfma_f32_16x16x32_bf16 v[80:83], v[200:203], v[144:147], v[80:83]
    v_exp_f32 v181, v181
    v_mfma_f32_16x16x32_bf16 v[84:87], v[200:203], v[148:151], v[84:87]
    ds_read_b128 a[208:211], v7 offset:34304
    v_cvt_pk_bf16_f32 v206, v180, v181
    v_mfma_f32_16x16x32_bf16 a[48:51], v[200:203], v[152:155], a[48:51]
    v_exp_f32 v182, v182
    v_mfma_f32_16x16x32_bf16 a[52:55], v[200:203], v[156:159], a[52:55]
    buffer_load_dwordx4 v3, s[8:11], s38 offen offset:1056 nt lds
    v_mfma_f32_16x16x32_bf16 a[56:59], v[200:203], v[160:163], a[56:59]
    v_exp_f32 v183, v183
    v_mfma_f32_16x16x32_bf16 a[60:63], v[200:203], v[164:167], a[60:63]
    ds_read_b128 a[212:215], v7 offset:34368
    v_cvt_pk_bf16_f32 v207, v182, v183
    v_mfma_f32_16x16x32_bf16 v[192:195], a[160:163], a[96:99], v[212:215]
    v_exp_f32 v184, v184
    v_mfma_f32_16x16x32_bf16 v[192:195], a[164:167], a[100:103], v[192:195]
    v_mfma_f32_16x16x32_bf16 v[192:195], a[168:171], a[104:107], v[192:195]
    v_exp_f32 v185, v185
    v_mfma_f32_16x16x32_bf16 v[192:195], a[172:175], a[108:111], v[192:195]
    ds_read_b128 a[216:219], v7 offset:34432
    v_smfmac_f32_16x16x64_bf16 v[240:243], a[248:251], v[200:207], v16
    v_cvt_pk_bf16_f32 v200, v184, v185
    v_mfma_f32_16x16x32_bf16 v[196:199], a[188:191], a[108:111], v[212:215]
    v_exp_f32 v186, v186
    v_mfma_f32_16x16x32_bf16 v[196:199], a[184:187], a[104:107], v[196:199]
    v_mfma_f32_16x16x32_bf16 v[196:199], a[180:183], a[100:103], v[196:199]
    v_exp_f32 v187, v187
    v_mfma_f32_16x16x32_bf16 v[196:199], a[176:179], a[96:99], v[196:199]
    ds_read_b128 a[220:223], v7 offset:34496
    v_cvt_pk_bf16_f32 v201, v186, v187
    v_mfma_f32_16x16x32_bf16 v[88:91], v[204:207], v[136:139], v[88:91]
    v_exp_f32 v188, v188
    v_mfma_f32_16x16x32_bf16 v[92:95], v[204:207], v[140:143], v[92:95]
    buffer_load_dwordx4 v4, s[8:11], s38 offen offset:2112 nt lds
    v_mfma_f32_16x16x32_bf16 v[96:99], v[204:207], v[144:147], v[96:99]
    v_exp_f32 v189, v189
    v_mfma_f32_16x16x32_bf16 v[100:103], v[204:207], v[148:151], v[100:103]
    ds_read_b64_tr_b16 v[136:137], v9 offset:50688
    v_cvt_pk_bf16_f32 v202, v188, v189
    v_mfma_f32_16x16x32_bf16 a[64:67], v[204:207], v[152:155], a[64:67]
    v_exp_f32 v190, v190
    v_mfma_f32_16x16x32_bf16 a[68:71], v[204:207], v[156:159], a[68:71]
    ds_read_b64_tr_b16 v[138:139], v9 offset:51200
    v_mfma_f32_16x16x32_bf16 a[72:75], v[204:207], v[160:163], a[72:75]
    v_exp_f32 v191, v191
    v_mfma_f32_16x16x32_bf16 a[76:79], v[204:207], v[164:167], a[76:79]
    ds_read_b64_tr_b16 v[140:141], v9 offset:50720
    v_cvt_pk_bf16_f32 v203, v190, v191
    v_mfma_f32_16x16x32_bf16 v[168:171], a[160:163], a[112:115], v[216:219]
    v_exp_f32 v192, v192
    v_mfma_f32_16x16x32_bf16 v[168:171], a[164:167], a[116:119], v[168:171]
    buffer_load_dwordx4 v5, s[8:11], s38 offen offset:3168 nt lds
    v_mfma_f32_16x16x32_bf16 v[168:171], a[168:171], a[120:123], v[168:171]
    v_exp_f32 v193, v193
    v_mfma_f32_16x16x32_bf16 v[168:171], a[172:175], a[124:127], v[168:171]
    ds_read_b64_tr_b16 v[142:143], v9 offset:51232
    v_cvt_pk_bf16_f32 v204, v192, v193
    v_mfma_f32_16x16x32_bf16 v[172:175], a[188:191], a[124:127], v[216:219]
    v_exp_f32 v194, v194
    v_mfma_f32_16x16x32_bf16 v[172:175], a[184:187], a[120:123], v[172:175]
    s_add_u32 m0, s40, 0x14a00
    v_mfma_f32_16x16x32_bf16 v[172:175], a[180:183], a[116:119], v[172:175]
    v_exp_f32 v195, v195
    v_mfma_f32_16x16x32_bf16 v[172:175], a[176:179], a[112:115], v[172:175]
    ds_read_b64_tr_b16 v[144:145], v9 offset:50752
    v_cvt_pk_bf16_f32 v205, v194, v195
    v_mfma_f32_16x16x32_bf16 v[24:27], v[200:203], v[104:107], v[24:27]
    v_exp_f32 v196, v196
    v_mfma_f32_16x16x32_bf16 v[28:31], v[200:203], v[108:111], v[28:31]
    ds_read_b64_tr_b16 v[146:147], v9 offset:51264
    v_mfma_f32_16x16x32_bf16 v[32:35], v[200:203], v[112:115], v[32:35]
    v_exp_f32 v197, v197
    v_mfma_f32_16x16x32_bf16 v[36:39], v[200:203], v[116:119], v[36:39]
    ds_read_b64_tr_b16 v[148:149], v9 offset:50784
    v_cvt_pk_bf16_f32 v206, v196, v197
    v_mfma_f32_16x16x32_bf16 a[0:3], v[200:203], v[120:123], a[0:3]
    v_exp_f32 v198, v198
    v_mfma_f32_16x16x32_bf16 a[4:7], v[200:203], v[124:127], a[4:7]
    buffer_load_dwordx4 v2, s[12:15], s38 offen nt lds
    v_mfma_f32_16x16x32_bf16 a[8:11], v[200:203], v[128:131], a[8:11]
    v_exp_f32 v199, v199
    v_mfma_f32_16x16x32_bf16 a[12:15], v[200:203], v[132:135], a[12:15]
    ds_read_b64_tr_b16 v[150:151], v9 offset:51296
    v_cvt_pk_bf16_f32 v207, v198, v199
    v_mfma_f32_16x16x32_bf16 v[176:179], a[160:163], a[128:131], v[220:223]
    v_exp_f32 v168, v168
    v_mfma_f32_16x16x32_bf16 v[176:179], a[164:167], a[132:135], v[176:179]
    s_waitcnt lgkmcnt(8)
    v_mfma_f32_16x16x32_bf16 v[176:179], a[168:171], a[136:139], v[176:179]
    v_exp_f32 v169, v169
    v_mfma_f32_16x16x32_bf16 v[176:179], a[172:175], a[140:143], v[176:179]
    ds_read_b64_tr_b16 v[152:153], v11 offset:50688
    v_smfmac_f32_16x16x64_bf16 v[240:243], a[224:227], v[200:207], v16
    v_cvt_pk_bf16_f32 v200, v168, v169
    v_mfma_f32_16x16x32_bf16 v[180:183], a[188:191], a[140:143], v[220:223]
    v_exp_f32 v170, v170
    v_mfma_f32_16x16x32_bf16 v[180:183], a[184:187], a[136:139], v[180:183]
    buffer_load_dwordx4 v3, s[12:15], s38 offen offset:1056 nt lds
    v_mfma_f32_16x16x32_bf16 v[180:183], a[180:183], a[132:135], v[180:183]
    v_exp_f32 v171, v171
    v_mfma_f32_16x16x32_bf16 v[180:183], a[176:179], a[128:131], v[180:183]
    ds_read_b64_tr_b16 v[154:155], v11 offset:51200
    v_cvt_pk_bf16_f32 v201, v170, v171
    v_mfma_f32_16x16x32_bf16 v[40:43], v[204:207], v[104:107], v[40:43]
    v_exp_f32 v172, v172
    v_mfma_f32_16x16x32_bf16 v[44:47], v[204:207], v[108:111], v[44:47]
    ds_read_b64_tr_b16 v[156:157], v11 offset:50720
    v_mfma_f32_16x16x32_bf16 v[48:51], v[204:207], v[112:115], v[48:51]
    v_exp_f32 v173, v173
    v_mfma_f32_16x16x32_bf16 v[52:55], v[204:207], v[116:119], v[52:55]
    ds_read_b64_tr_b16 v[158:159], v11 offset:51232
    v_cvt_pk_bf16_f32 v202, v172, v173
    v_mfma_f32_16x16x32_bf16 a[16:19], v[204:207], v[120:123], a[16:19]
    v_exp_f32 v174, v174
    v_mfma_f32_16x16x32_bf16 a[20:23], v[204:207], v[124:127], a[20:23]
    v_mfma_f32_16x16x32_bf16 a[24:27], v[204:207], v[128:131], a[24:27]
    v_exp_f32 v175, v175
    v_mfma_f32_16x16x32_bf16 a[28:31], v[204:207], v[132:135], a[28:31]
    ds_read_b64_tr_b16 v[160:161], v11 offset:50752
    v_cvt_pk_bf16_f32 v203, v174, v175
    v_mfma_f32_16x16x32_bf16 v[184:187], a[160:163], a[144:147], v[224:227]
    v_exp_f32 v176, v176
    v_mfma_f32_16x16x32_bf16 v[184:187], a[164:167], a[148:151], v[184:187]
    buffer_load_dwordx4 v4, s[12:15], s38 offen offset:2112 nt lds
    v_mfma_f32_16x16x32_bf16 v[184:187], a[168:171], a[152:155], v[184:187]
    v_exp_f32 v177, v177
    v_mfma_f32_16x16x32_bf16 v[184:187], a[172:175], a[156:159], v[184:187]
    ds_read_b64_tr_b16 v[162:163], v11 offset:51264
    v_cvt_pk_bf16_f32 v204, v176, v177
    v_mfma_f32_16x16x32_bf16 v[188:191], a[188:191], a[156:159], v[224:227]
    v_exp_f32 v178, v178
    v_mfma_f32_16x16x32_bf16 v[188:191], a[184:187], a[152:155], v[188:191]
    ds_read_b64_tr_b16 v[164:165], v11 offset:50784
    v_mfma_f32_16x16x32_bf16 v[188:191], a[180:183], a[148:151], v[188:191]
    v_exp_f32 v179, v179
    v_mfma_f32_16x16x32_bf16 v[188:191], a[176:179], a[144:147], v[188:191]
    ds_read_b64_tr_b16 v[166:167], v11 offset:51296
    v_cvt_pk_bf16_f32 v205, v178, v179
    v_mfma_f32_16x16x32_bf16 v[56:59], v[200:203], v[104:107], v[56:59]
    v_exp_f32 v180, v180
    v_mfma_f32_16x16x32_bf16 v[60:63], v[200:203], v[108:111], v[60:63]
    buffer_load_dwordx4 v5, s[12:15], s38 offen offset:3168 nt lds
    v_mfma_f32_16x16x32_bf16 v[64:67], v[200:203], v[112:115], v[64:67]
    v_exp_f32 v181, v181
    v_mfma_f32_16x16x32_bf16 v[68:71], v[200:203], v[116:119], v[68:71]
    v_cvt_pk_bf16_f32 v206, v180, v181
    v_mfma_f32_16x16x32_bf16 a[32:35], v[200:203], v[120:123], a[32:35]
    v_exp_f32 v182, v182
    v_mfma_f32_16x16x32_bf16 a[36:39], v[200:203], v[124:127], a[36:39]
    s_add_u32 s38, s38, s39
    s_add_u32 m0, s40, 0x18c00
    v_mfma_f32_16x16x32_bf16 a[40:43], v[200:203], v[128:131], a[40:43]
    v_exp_f32 v183, v183
    v_mfma_f32_16x16x32_bf16 a[44:47], v[200:203], v[132:135], a[44:47]
    v_cvt_pk_bf16_f32 v207, v182, v183
    s_cbranch_vccnz L_epi
    v_mfma_f32_16x16x32_bf16 v[192:195], a[192:195], a[80:83], v[208:211]
    v_exp_f32 v184, v184
    v_mfma_f32_16x16x32_bf16 v[192:195], a[196:199], a[84:87], v[192:195]
    s_waitcnt vmcnt(16) lgkmcnt(0)
    s_barrier
    v_mfma_f32_16x16x32_bf16 v[192:195], a[200:203], a[88:91], v[192:195]
    v_exp_f32 v185, v185
    v_mfma_f32_16x16x32_bf16 v[192:195], a[204:207], a[92:95], v[192:195]
    ds_read_b128 a[160:163], v6
    v_smfmac_f32_16x16x64_bf16 v[240:243], a[228:231], v[200:207], v16
    v_cvt_pk_bf16_f32 v200, v184, v185
    v_mfma_f32_16x16x32_bf16 v[196:199], a[220:223], a[92:95], v[208:211]
    v_exp_f32 v186, v186
    v_mfma_f32_16x16x32_bf16 v[196:199], a[216:219], a[88:91], v[196:199]
    buffer_load_dwordx4 v2, s[8:11], s38 offen nt lds
    v_mfma_f32_16x16x32_bf16 v[196:199], a[212:215], a[84:87], v[196:199]
    v_exp_f32 v187, v187
    v_mfma_f32_16x16x32_bf16 v[196:199], a[208:211], a[80:83], v[196:199]
    ds_read_b128 a[164:167], v6 offset:64
    v_cvt_pk_bf16_f32 v201, v186, v187
    v_mfma_f32_16x16x32_bf16 v[72:75], v[204:207], v[104:107], v[72:75]
    v_exp_f32 v188, v188
    v_mfma_f32_16x16x32_bf16 v[76:79], v[204:207], v[108:111], v[76:79]
    ds_read_b128 a[168:171], v6 offset:128
    ds_read_b128 a[172:175], v6 offset:192
    v_mfma_f32_16x16x32_bf16 v[80:83], v[204:207], v[112:115], v[80:83]
    v_exp_f32 v189, v189
    v_mfma_f32_16x16x32_bf16 v[84:87], v[204:207], v[116:119], v[84:87]
    ds_read_b128 a[176:179], v6 offset:512
    v_cvt_pk_bf16_f32 v202, v188, v189
    v_mfma_f32_16x16x32_bf16 a[48:51], v[204:207], v[120:123], a[48:51]
    v_exp_f32 v190, v190
    v_mfma_f32_16x16x32_bf16 a[52:55], v[204:207], v[124:127], a[52:55]
    buffer_load_dwordx4 v3, s[8:11], s38 offen offset:1056 nt lds
    v_mfma_f32_16x16x32_bf16 a[56:59], v[204:207], v[128:131], a[56:59]
    v_exp_f32 v191, v191
    v_mfma_f32_16x16x32_bf16 a[60:63], v[204:207], v[132:135], a[60:63]
    ds_read_b128 a[180:183], v6 offset:576
    v_cvt_pk_bf16_f32 v203, v190, v191
    v_mfma_f32_16x16x32_bf16 v[168:171], a[192:195], a[96:99], v[212:215]
    v_exp_f32 v192, v192
    v_mfma_f32_16x16x32_bf16 v[168:171], a[196:199], a[100:103], v[168:171]
    s_add_u32 s3, s3, 0x1400
    v_mfma_f32_16x16x32_bf16 v[168:171], a[200:203], a[104:107], v[168:171]
    v_exp_f32 v193, v193
    v_mfma_f32_16x16x32_bf16 v[168:171], a[204:207], a[108:111], v[168:171]
    ds_read_b128 a[184:187], v6 offset:640
    v_cvt_pk_bf16_f32 v204, v192, v193
    v_mfma_f32_16x16x32_bf16 v[172:175], a[220:223], a[108:111], v[212:215]
    v_exp_f32 v194, v194
    v_mfma_f32_16x16x32_bf16 v[172:175], a[216:219], a[104:107], v[172:175]
    v_mfma_f32_16x16x32_bf16 v[172:175], a[212:215], a[100:103], v[172:175]
    v_exp_f32 v195, v195
    v_mfma_f32_16x16x32_bf16 v[172:175], a[208:211], a[96:99], v[172:175]
    ds_read_b128 a[188:191], v6 offset:704
    v_cvt_pk_bf16_f32 v205, v194, v195
    v_mfma_f32_16x16x32_bf16 v[88:91], v[200:203], v[104:107], v[88:91]
    v_exp_f32 v196, v196
    v_mfma_f32_16x16x32_bf16 v[92:95], v[200:203], v[108:111], v[92:95]
    buffer_load_dwordx4 v4, s[8:11], s38 offen offset:2112 nt lds
    v_mfma_f32_16x16x32_bf16 v[96:99], v[200:203], v[112:115], v[96:99]
    v_exp_f32 v197, v197
    v_mfma_f32_16x16x32_bf16 v[100:103], v[200:203], v[116:119], v[100:103]
    ds_read_b64_tr_b16 v[104:105], v8 offset:16896
    v_cvt_pk_bf16_f32 v206, v196, v197
    v_mfma_f32_16x16x32_bf16 a[64:67], v[200:203], v[120:123], a[64:67]
    v_exp_f32 v198, v198
    v_mfma_f32_16x16x32_bf16 a[68:71], v[200:203], v[124:127], a[68:71]
    ds_read_b64_tr_b16 v[106:107], v8 offset:17408
    v_mfma_f32_16x16x32_bf16 a[72:75], v[200:203], v[128:131], a[72:75]
    v_exp_f32 v199, v199
    v_mfma_f32_16x16x32_bf16 a[76:79], v[200:203], v[132:135], a[76:79]
    ds_read_b64_tr_b16 v[108:109], v8 offset:16928
    v_cvt_pk_bf16_f32 v207, v198, v199
    v_mfma_f32_16x16x32_bf16 v[176:179], a[192:195], a[112:115], v[216:219]
    v_exp_f32 v168, v168
    v_mfma_f32_16x16x32_bf16 v[176:179], a[196:199], a[116:119], v[176:179]
    buffer_load_dwordx4 v5, s[8:11], s38 offen offset:3168 nt lds
    v_mfma_f32_16x16x32_bf16 v[176:179], a[200:203], a[120:123], v[176:179]
    v_exp_f32 v169, v169
    v_mfma_f32_16x16x32_bf16 v[176:179], a[204:207], a[124:127], v[176:179]
    ds_read_b64_tr_b16 v[110:111], v8 offset:17440
    v_smfmac_f32_16x16x64_bf16 v[240:243], a[232:235], v[200:207], v16
    v_cvt_pk_bf16_f32 v200, v168, v169
    v_mfma_f32_16x16x32_bf16 v[180:183], a[220:223], a[124:127], v[216:219]
    v_exp_f32 v170, v170
    v_mfma_f32_16x16x32_bf16 v[180:183], a[216:219], a[120:123], v[180:183]
    s_add_u32 m0, s40, 0x1ce00
    v_mfma_f32_16x16x32_bf16 v[180:183], a[212:215], a[116:119], v[180:183]
    v_exp_f32 v171, v171
    v_mfma_f32_16x16x32_bf16 v[180:183], a[208:211], a[112:115], v[180:183]
    ds_read_b64_tr_b16 v[112:113], v8 offset:16960
    v_cvt_pk_bf16_f32 v201, v170, v171
    v_mfma_f32_16x16x32_bf16 v[24:27], v[204:207], v[136:139], v[24:27]
    v_exp_f32 v172, v172
    v_mfma_f32_16x16x32_bf16 v[28:31], v[204:207], v[140:143], v[28:31]
    ds_read_b64_tr_b16 v[114:115], v8 offset:17472
    v_mfma_f32_16x16x32_bf16 v[32:35], v[204:207], v[144:147], v[32:35]
    v_exp_f32 v173, v173
    v_mfma_f32_16x16x32_bf16 v[36:39], v[204:207], v[148:151], v[36:39]
    ds_read_b64_tr_b16 v[116:117], v8 offset:16992
    v_cvt_pk_bf16_f32 v202, v172, v173
    v_mfma_f32_16x16x32_bf16 a[0:3], v[204:207], v[152:155], a[0:3]
    v_exp_f32 v174, v174
    v_mfma_f32_16x16x32_bf16 a[4:7], v[204:207], v[156:159], a[4:7]
    buffer_load_dwordx4 v2, s[12:15], s38 offen nt lds
    v_mfma_f32_16x16x32_bf16 a[8:11], v[204:207], v[160:163], a[8:11]
    v_exp_f32 v175, v175
    v_mfma_f32_16x16x32_bf16 a[12:15], v[204:207], v[164:167], a[12:15]
    ds_read_b64_tr_b16 v[118:119], v8 offset:17504
    v_cvt_pk_bf16_f32 v203, v174, v175
    v_mfma_f32_16x16x32_bf16 v[184:187], a[192:195], a[128:131], v[220:223]
    v_exp_f32 v176, v176
    v_mfma_f32_16x16x32_bf16 v[184:187], a[196:199], a[132:135], v[184:187]
    s_waitcnt lgkmcnt(8)
    v_mfma_f32_16x16x32_bf16 v[184:187], a[200:203], a[136:139], v[184:187]
    v_exp_f32 v177, v177
    v_mfma_f32_16x16x32_bf16 v[184:187], a[204:207], a[140:143], v[184:187]
    ds_read_b64_tr_b16 v[120:121], v10 offset:16896
    v_cvt_pk_bf16_f32 v204, v176, v177
    v_mfma_f32_16x16x32_bf16 v[188:191], a[220:223], a[140:143], v[220:223]
    v_exp_f32 v178, v178
    v_mfma_f32_16x16x32_bf16 v[188:191], a[216:219], a[136:139], v[188:191]
    buffer_load_dwordx4 v3, s[12:15], s38 offen offset:1056 nt lds
    v_mfma_f32_16x16x32_bf16 v[188:191], a[212:215], a[132:135], v[188:191]
    v_exp_f32 v179, v179
    v_mfma_f32_16x16x32_bf16 v[188:191], a[208:211], a[128:131], v[188:191]
    ds_read_b64_tr_b16 v[122:123], v10 offset:17408
    v_cvt_pk_bf16_f32 v205, v178, v179
    v_mfma_f32_16x16x32_bf16 v[40:43], v[200:203], v[136:139], v[40:43]
    v_exp_f32 v180, v180
    v_mfma_f32_16x16x32_bf16 v[44:47], v[200:203], v[140:143], v[44:47]
    ds_read_b64_tr_b16 v[124:125], v10 offset:16928
    v_mfma_f32_16x16x32_bf16 v[48:51], v[200:203], v[144:147], v[48:51]
    v_exp_f32 v181, v181
    v_mfma_f32_16x16x32_bf16 v[52:55], v[200:203], v[148:151], v[52:55]
    ds_read_b64_tr_b16 v[126:127], v10 offset:17440
    v_cvt_pk_bf16_f32 v206, v180, v181
    v_mfma_f32_16x16x32_bf16 a[16:19], v[200:203], v[152:155], a[16:19]
    v_exp_f32 v182, v182
    v_mfma_f32_16x16x32_bf16 a[20:23], v[200:203], v[156:159], a[20:23]
    v_mfma_f32_16x16x32_bf16 a[24:27], v[200:203], v[160:163], a[24:27]
    v_exp_f32 v183, v183
    v_mfma_f32_16x16x32_bf16 a[28:31], v[200:203], v[164:167], a[28:31]
    ds_read_b64_tr_b16 v[128:129], v10 offset:16960
    v_cvt_pk_bf16_f32 v207, v182, v183
    v_mfma_f32_16x16x32_bf16 v[192:195], a[192:195], a[144:147], v[224:227]
    v_exp_f32 v184, v184
    v_mfma_f32_16x16x32_bf16 v[192:195], a[196:199], a[148:151], v[192:195]
    buffer_load_dwordx4 v4, s[12:15], s38 offen offset:2112 nt lds
    v_mfma_f32_16x16x32_bf16 v[192:195], a[200:203], a[152:155], v[192:195]
    v_exp_f32 v185, v185
    v_mfma_f32_16x16x32_bf16 v[192:195], a[204:207], a[156:159], v[192:195]
    ds_read_b64_tr_b16 v[130:131], v10 offset:17472
    v_smfmac_f32_16x16x64_bf16 v[240:243], a[236:239], v[200:207], v16
    v_cvt_pk_bf16_f32 v200, v184, v185
    v_mfma_f32_16x16x32_bf16 v[196:199], a[220:223], a[156:159], v[224:227]
    v_exp_f32 v186, v186
    v_mfma_f32_16x16x32_bf16 v[196:199], a[216:219], a[152:155], v[196:199]
    ds_read_b64_tr_b16 v[132:133], v10 offset:16992
    v_mfma_f32_16x16x32_bf16 v[196:199], a[212:215], a[148:151], v[196:199]
    v_exp_f32 v187, v187
    v_mfma_f32_16x16x32_bf16 v[196:199], a[208:211], a[144:147], v[196:199]
    ds_read_b64_tr_b16 v[134:135], v10 offset:17504
    v_cvt_pk_bf16_f32 v201, v186, v187
    v_mfma_f32_16x16x32_bf16 v[56:59], v[204:207], v[136:139], v[56:59]
    v_exp_f32 v188, v188
    v_mfma_f32_16x16x32_bf16 v[60:63], v[204:207], v[140:143], v[60:63]
    buffer_load_dwordx4 v5, s[12:15], s38 offen offset:3168 nt lds
    v_mfma_f32_16x16x32_bf16 v[64:67], v[204:207], v[144:147], v[64:67]
    v_exp_f32 v189, v189
    v_mfma_f32_16x16x32_bf16 v[68:71], v[204:207], v[148:151], v[68:71]
    v_cvt_pk_bf16_f32 v202, v188, v189
    v_mfma_f32_16x16x32_bf16 a[32:35], v[204:207], v[152:155], a[32:35]
    v_exp_f32 v190, v190
    v_mfma_f32_16x16x32_bf16 a[36:39], v[204:207], v[156:159], a[36:39]
    s_add_u32 s38, s38, s39
    s_add_u32 m0, s40, 0
    v_mfma_f32_16x16x32_bf16 a[40:43], v[204:207], v[160:163], a[40:43]
    v_exp_f32 v191, v191
    v_mfma_f32_16x16x32_bf16 a[44:47], v[204:207], v[164:167], a[44:47]
    v_cvt_pk_bf16_f32 v203, v190, v191
    s_sub_u32 s37, s37, 1
    s_cbranch_scc0 L_loop
    s_cmp_eq_u32 s43, 0
    s_cbranch_scc1 L_ann
    s_mov_b64 vcc, -1
    s_mov_b32 s8, s20
    s_mov_b32 s9, s21
    s_mov_b32 s10, s22
    s_add_u32 s12, s20, 0x8000
    s_addc_u32 s13, s21, 0
    s_sub_u32 s14, s22, 0x8000
    s_mov_b32 s39, 0x10000
    s_lshl_b32 s38, s35, 18
    v_accvgpr_read_b32 v2, a240
    v_accvgpr_read_b32 v3, a241
    v_accvgpr_read_b32 v4, a242
    v_accvgpr_read_b32 v5, a243
    s_cmp_lg_u32 s32, 0
    s_cbranch_scc1 L_loop
    buffer_load_dwordx2 v[236:237], v1, s[4:7], s70 offen sc1
    s_branch L_loop
L_epi:
    v_mfma_f32_16x16x32_bf16 v[192:195], a[192:195], a[80:83], v[208:211]
    v_exp_f32 v184, v184
    v_mfma_f32_16x16x32_bf16 v[192:195], a[196:199], a[84:87], v[192:195]
    s_waitcnt lgkmcnt(0)
    s_barrier
    v_mfma_f32_16x16x32_bf16 v[192:195], a[200:203], a[88:91], v[192:195]
    v_exp_f32 v185, v185
    v_mfma_f32_16x16x32_bf16 v[192:195], a[204:207], a[92:95], v[192:195]
    buffer_load_dwordx4 v2, s[8:11], s38 offen nt lds
    v_readfirstlane_b32 s45, v234
    v_smfmac_f32_16x16x64_bf16 v[240:243], a[228:231], v[200:207], v16
    v_cvt_pk_bf16_f32 v200, v184, v185
    v_accvgpr_read_b32 v21, a252
    v_mfma_f32_16x16x32_bf16 v[196:199], a[220:223], a[92:95], v[208:211]
    v_exp_f32 v186, v186
    v_mfma_f32_16x16x32_bf16 v[196:199], a[216:219], a[88:91], v[196:199]
    v_exp_f32 v187, v187
    v_mfma_f32_16x16x32_bf16 v[196:199], a[212:215], a[84:87], v[196:199]
    buffer_load_dwordx4 v3, s[8:11], s38 offen offset:1056 nt lds
    v_cvt_pk_bf16_f32 v201, v186, v187
    v_mfma_f32_16x16x32_bf16 v[196:199], a[208:211], a[80:83], v[196:199]
    v_exp_f32 v188, v188
    v_mfma_f32_16x16x32_bf16 v[72:75], v[204:207], v[104:107], v[72:75]
    v_exp_f32 v189, v189
    v_mfma_f32_16x16x32_bf16 v[76:79], v[204:207], v[108:111], v[76:79]
    v_cvt_pk_bf16_f32 v202, v188, v189
    v_readfirstlane_b32 s46, v236
    v_mfma_f32_16x16x32_bf16 v[80:83], v[204:207], v[112:115], v[80:83]
    buffer_load_dwordx4 v4, s[8:11], s38 offen offset:2112 nt lds
    v_accvgpr_read_b32 v17, a254
    v_mfma_f32_16x16x32_bf16 v[84:87], v[204:207], v[116:119], v[84:87]
    v_exp_f32 v190, v190
    v_mfma_f32_16x16x32_bf16 a[48:51], v[204:207], v[120:123], a[48:51]
    v_exp_f32 v191, v191
    v_mfma_f32_16x16x32_bf16 a[52:55], v[204:207], v[124:127], a[52:55]
    v_cvt_pk_bf16_f32 v203, v190, v191
    v_mov_b32 v22, 160256
    v_mfma_f32_16x16x32_bf16 a[56:59], v[204:207], v[128:131], a[56:59]
    buffer_load_dwordx4 v5, s[8:11], s38 offen offset:3168 nt lds
    s_and_b32 s51, s45, 15
    v_mfma_f32_16x16x32_bf16 a[60:63], v[204:207], v[132:135], a[60:63]
    s_add_u32 m0, s40, 0x1ce00
    v_mfma_f32_16x16x32_bf16 v[168:171], a[192:195], a[96:99], v[212:215]
    v_exp_f32 v192, v192
    v_mfma_f32_16x16x32_bf16 v[168:171], a[196:199], a[100:103], v[168:171]
    v_exp_f32 v193, v193
    v_mfma_f32_16x16x32_bf16 v[168:171], a[200:203], a[104:107], v[168:171]
    buffer_load_dwordx4 v2, s[12:15], s38 offen nt lds
    v_cvt_pk_bf16_f32 v204, v192, v193
    v_mfma_f32_16x16x32_bf16 v[168:171], a[204:207], a[108:111], v[168:171]
    v_exp_f32 v194, v194
    v_mfma_f32_16x16x32_bf16 v[172:175], a[220:223], a[108:111], v[212:215]
    v_exp_f32 v195, v195
    v_mfma_f32_16x16x32_bf16 v[172:175], a[216:219], a[104:107], v[172:175]
    v_exp_f32 v196, v196
    v_mfma_f32_16x16x32_bf16 v[172:175], a[212:215], a[100:103], v[172:175]
    buffer_load_dwordx4 v3, s[12:15], s38 offen offset:1056 nt lds
    v_cvt_pk_bf16_f32 v205, v194, v195
    v_mfma_f32_16x16x32_bf16 v[172:175], a[208:211], a[96:99], v[172:175]
    v_exp_f32 v197, v197
    v_mfma_f32_16x16x32_bf16 a[64:67], v[200:203], v[120:123], a[64:67]
    v_exp_f32 v198, v198
    v_mfma_f32_16x16x32_bf16 a[68:71], v[200:203], v[124:127], a[68:71]
    v_exp_f32 v199, v199
    v_mfma_f32_16x16x32_bf16 a[72:75], v[200:203], v[128:131], a[72:75]
    v_cvt_pk_bf16_f32 v206, v196, v197
    v_cvt_pk_bf16_f32 v207, v198, v199
    v_mfma_f32_16x16x32_bf16 a[76:79], v[200:203], v[132:135], a[76:79]
    buffer_load_dwordx4 v4, s[12:15], s38 offen offset:2112 nt lds
    v_exp_f32 v168, v168
    v_mfma_f32_16x16x32_bf16 a[0:3], v[204:207], v[152:155], a[0:3]
    v_exp_f32 v169, v169
    v_mfma_f32_16x16x32_bf16 a[4:7], v[204:207], v[156:159], a[4:7]
    s_cmp_eq_u32 s51, 15
    s_cselect_b32 s51, s45, 0
    s_and_b32 s51, s51, 0xffff0000
    s_and_b32 s46, s46, 15
    s_cselect_b32 s46, 2, 0
    s_or_b32 s51, s51, s46
    v_mfma_f32_16x16x32_bf16 a[8:11], v[204:207], v[160:163], a[8:11]
    v_exp_f32 v170, v170
    ds_write_b128 v248, a[0:3]
    v_mfma_f32_16x16x32_bf16 a[12:15], v[204:207], v[164:167], a[12:15]
    buffer_load_dwordx4 v5, s[12:15], s38 offen offset:3168 nt lds
    v_cvt_pk_bf16_f32 v208, v168, v169
    v_mfma_f32_16x16x32_bf16 v[176:179], a[192:195], a[112:115], v[216:219]
    v_exp_f32 v171, v171
    s_waitcnt vmcnt(12)
    ds_write_b128 v248, a[4:7] offset:1024
    v_mfma_f32_16x16x32_bf16 v[176:179], a[196:199], a[116:119], v[176:179]
    v_exp_f32 v172, v172
    ds_read_b64_tr_b16 a[160:161], v244
    v_mfma_f32_16x16x32_bf16 v[176:179], a[200:203], a[120:123], v[176:179]
    ds_read_b64_tr_b16 a[162:163], v244 offset:2112
    v_cvt_pk_bf16_f32 v209, v170, v171
    v_mfma_f32_16x16x32_bf16 v[176:179], a[204:207], a[124:127], v[176:179]
    v_exp_f32 v173, v173
    ds_read_b64_tr_b16 a[164:165], v245
    ds_write_b128 v248, a[8:11] offset:2048
    v_mfma_f32_16x16x32_bf16 v[180:183], a[220:223], a[124:127], v[216:219]
    v_exp_f32 v174, v174
    v_mfma_f32_16x16x32_bf16 v[180:183], a[216:219], a[120:123], v[180:183]
    ds_read_b64_tr_b16 a[166:167], v245 offset:2112
    ds_write_b128 v248, a[12:15] offset:3072
    v_mfma_f32_16x16x32_bf16 v[180:183], a[212:215], a[116:119], v[180:183]
    v_cvt_pk_bf16_f32 v210, v172, v173
    v_exp_f32 v175, v175
    ds_read_b64_tr_b16 a[168:169], v246
    v_mfma_f32_16x16x32_bf16 v[180:183], a[208:211], a[112:115], v[180:183]
    v_cvt_pk_bf16_f32 v211, v174, v175
    ds_read_b64_tr_b16 a[170:171], v246 offset:2112
    v_smfmac_f32_16x16x64_bf16 v[240:243], a[232:235], v[200:207], v16
    v_exp_f32 v176, v176
    ds_read_b64_tr_b16 a[172:173], v247
    v_mfma_f32_16x16x32_bf16 a[16:19], v[208:211], v[152:155], a[16:19]
    v_exp_f32 v177, v177
    v_mfma_f32_16x16x32_bf16 a[20:23], v[208:211], v[156:159], a[20:23]
    ds_read_b64_tr_b16 a[174:175], v247 offset:2112
    v_cvt_pk_bf16_f32 v212, v176, v177
    v_mfma_f32_16x16x32_bf16 a[24:27], v[208:211], v[160:163], a[24:27]
    v_exp_f32 v178, v178
    ds_write_b128 v19, a[16:19]
    v_mfma_f32_16x16x32_bf16 a[28:31], v[208:211], v[164:167], a[28:31]
    v_exp_f32 v179, v179
    s_waitcnt vmcnt(8)
    v_mfma_f32_16x16x32_bf16 v[184:187], a[192:195], a[128:131], v[220:223]
    v_exp_f32 v180, v180
    ds_read_b64_tr_b16 a[176:177], v244 offset:16896
    ds_write_b128 v19, a[20:23] offset:1024
    v_mfma_f32_16x16x32_bf16 v[184:187], a[196:199], a[132:135], v[184:187]
    ds_read_b64_tr_b16 a[178:179], v244 offset:19008
    v_cvt_pk_bf16_f32 v213, v178, v179
    v_mfma_f32_16x16x32_bf16 v[184:187], a[200:203], a[136:139], v[184:187]
    v_exp_f32 v181, v181
    ds_read_b64_tr_b16 a[180:181], v245 offset:16896
    v_mfma_f32_16x16x32_bf16 v[184:187], a[204:207], a[140:143], v[184:187]
    v_exp_f32 v182, v182
    ds_write_b128 v19, a[24:27] offset:2048
    v_mfma_f32_16x16x32_bf16 v[188:191], a[220:223], a[140:143], v[220:223]
    ds_read_b64_tr_b16 a[182:183], v245 offset:19008
    v_cvt_pk_bf16_f32 v214, v180, v181
    v_mfma_f32_16x16x32_bf16 v[188:191], a[216:219], a[136:139], v[188:191]
    v_exp_f32 v183, v183
    ds_read_b64_tr_b16 a[184:185], v246 offset:16896
    ds_write_b128 v19, a[28:31] offset:3072
    v_mfma_f32_16x16x32_bf16 v[188:191], a[212:215], a[132:135], v[188:191]
    v_cvt_pk_bf16_f32 v215, v182, v183
    ds_read_b64_tr_b16 a[186:187], v246 offset:19008
    v_mfma_f32_16x16x32_bf16 v[188:191], a[208:211], a[128:131], v[188:191]
    v_exp_f32 v184, v184
    ds_read_b64_tr_b16 a[188:189], v247 offset:16896
    v_mfma_f32_16x16x32_bf16 a[32:35], v[212:215], v[152:155], a[32:35]
    v_exp_f32 v185, v185
    v_mfma_f32_16x16x32_bf16 a[36:39], v[212:215], v[156:159], a[36:39]
    ds_read_b64_tr_b16 a[190:191], v247 offset:19008
    v_cvt_pk_bf16_f32 v216, v184, v185
    v_mfma_f32_16x16x32_bf16 a[40:43], v[212:215], v[160:163], a[40:43]
    v_exp_f32 v186, v186
    ds_write_b128 v19, a[32:35] offset:16896
    v_mfma_f32_16x16x32_bf16 a[44:47], v[212:215], v[164:167], a[44:47]
    v_exp_f32 v187, v187
    v_mfma_f32_16x16x32_bf16 v[192:195], a[192:195], a[144:147], v[224:227]
    ds_write_b128 v19, a[36:39] offset:17920
    v_cvt_pk_bf16_f32 v217, v186, v187
    v_mfma_f32_16x16x32_bf16 v[192:195], a[196:199], a[148:151], v[192:195]
    v_exp_f32 v188, v188
    v_mfma_f32_16x16x32_bf16 v[192:195], a[200:203], a[152:155], v[192:195]
    v_exp_f32 v189, v189
    v_mfma_f32_16x16x32_bf16 v[192:195], a[204:207], a[156:159], v[192:195]
    s_waitcnt vmcnt(4)
    ds_read_b64_tr_b16 a[192:193], v244 offset:33792
    ds_write_b128 v19, a[40:43] offset:18944
    v_mfma_f32_16x16x32_bf16 v[196:199], a[220:223], a[156:159], v[224:227]
    v_exp_f32 v190, v190
    ds_read_b64_tr_b16 a[194:195], v244 offset:35904
    v_mfma_f32_16x16x32_bf16 v[196:199], a[216:219], a[152:155], v[196:199]
    ds_read_b64_tr_b16 a[196:197], v245 offset:33792
    ds_write_b128 v19, a[44:47] offset:19968
    v_mfma_f32_16x16x32_bf16 v[196:199], a[212:215], a[148:151], v[196:199]
    v_cvt_pk_bf16_f32 v218, v188, v189
    v_exp_f32 v191, v191
    ds_read_b64_tr_b16 a[198:199], v245 offset:35904
    v_mfma_f32_16x16x32_bf16 v[196:199], a[208:211], a[144:147], v[196:199]
    v_cvt_pk_bf16_f32 v219, v190, v191
    ds_read_b64_tr_b16 a[200:201], v246 offset:33792
    v_smfmac_f32_16x16x64_bf16 v[240:243], a[236:239], v[208:215], v16
    v_exp_f32 v192, v192
    ds_read_b64_tr_b16 a[202:203], v246 offset:35904
    v_mfma_f32_16x16x32_bf16 a[48:51], v[216:219], v[152:155], a[48:51]
    v_exp_f32 v193, v193
    ds_read_b64_tr_b16 a[204:205], v247 offset:33792
    v_mfma_f32_16x16x32_bf16 a[52:55], v[216:219], v[156:159], a[52:55]
    ds_read_b64_tr_b16 a[206:207], v247 offset:35904
    v_cvt_pk_bf16_f32 v220, v192, v193
    v_mfma_f32_16x16x32_bf16 a[56:59], v[216:219], v[160:163], a[56:59]
    v_exp_f32 v194, v194
    ds_write_b128 v19, a[48:51] offset:33792
    v_mfma_f32_16x16x32_bf16 a[60:63], v[216:219], v[164:167], a[60:63]
    v_exp_f32 v195, v195
    v_mfma_f32_16x16x32_bf16 v[88:91], v[200:203], v[104:107], v[88:91]
    v_exp_f32 v196, v196
    s_waitcnt vmcnt(0)
    ds_write_b128 v19, a[52:55] offset:34816
    v_mfma_f32_16x16x32_bf16 v[92:95], v[200:203], v[108:111], v[92:95]
    ds_read_b64_tr_b16 a[208:209], v244 offset:50688
    v_cvt_pk_bf16_f32 v221, v194, v195
    v_mfma_f32_16x16x32_bf16 v[96:99], v[200:203], v[112:115], v[96:99]
    v_exp_f32 v197, v197
    ds_read_b64_tr_b16 a[210:211], v244 offset:52800
    v_mfma_f32_16x16x32_bf16 v[100:103], v[200:203], v[116:119], v[100:103]
    v_exp_f32 v198, v198
    ds_read_b64_tr_b16 a[212:213], v245 offset:50688
    ds_write_b128 v19, a[56:59] offset:35840
    v_mfma_f32_16x16x32_bf16 v[24:27], v[204:207], v[136:139], v[24:27]
    v_cvt_pk_bf16_f32 v222, v196, v197
    ds_read_b64_tr_b16 a[214:215], v245 offset:52800
    v_mfma_f32_16x16x32_bf16 v[28:31], v[204:207], v[140:143], v[28:31]
    v_exp_f32 v199, v199
    ds_write_b128 v19, a[60:63] offset:36864
    v_mfma_f32_16x16x32_bf16 v[32:35], v[204:207], v[144:147], v[32:35]
    v_cvt_pk_bf16_f32 v223, v198, v199
    ds_read_b64_tr_b16 a[216:217], v246 offset:50688
    v_mfma_f32_16x16x32_bf16 v[36:39], v[204:207], v[148:151], v[36:39]
    ds_read_b64_tr_b16 a[218:219], v246 offset:52800
    ds_read_b64_tr_b16 a[220:221], v247 offset:50688
    v_smfmac_f32_16x16x64_bf16 v[240:243], a[248:251], v[216:223], v16
    ds_read_b64_tr_b16 a[222:223], v247 offset:52800
    v_mfma_f32_16x16x32_bf16 a[64:67], v[220:223], v[152:155], a[64:67]
    v_mfma_f32_16x16x32_bf16 a[68:71], v[220:223], v[156:159], a[68:71]
    v_add_f32 v232, v240, v241
    v_add_f32 v233, v242, v243
    ds_write_b64 v250, v[232:233]
    v_mfma_f32_16x16x32_bf16 a[72:75], v[220:223], v[160:163], a[72:75]
    ds_write_b128 v19, a[64:67] offset:50688
    v_mfma_f32_16x16x32_bf16 a[76:79], v[220:223], v[164:167], a[76:79]
    v_mfma_f32_16x16x32_bf16 v[40:43], v[208:211], v[136:139], v[40:43]
    s_waitcnt lgkmcnt(1)
    s_barrier
    ds_read_b64 v[238:239], v251
    ds_write_b128 v19, a[68:71] offset:51712
    v_mfma_f32_16x16x32_bf16 v[44:47], v[208:211], v[140:143], v[44:47]
    ds_read_b128 v[104:107], v249
    ds_read_b128 v[108:111], v249 offset:1024
    v_mfma_f32_16x16x32_bf16 v[48:51], v[208:211], v[144:147], v[48:51]
    ds_read_b128 v[112:115], v249 offset:2048
    ds_read_b128 v[116:119], v249 offset:3072
    v_mfma_f32_16x16x32_bf16 v[52:55], v[208:211], v[148:151], v[52:55]
    ds_read_b128 v[120:123], v20
    ds_read_b128 v[124:127], v20 offset:1024
    ds_write_b128 v19, a[72:75] offset:52736
    v_mfma_f32_16x16x32_bf16 v[56:59], v[212:215], v[136:139], v[56:59]
    ds_read_b128 v[128:131], v20 offset:2048
    ds_read_b128 v[132:135], v20 offset:3072
    v_mfma_f32_16x16x32_bf16 v[60:63], v[212:215], v[140:143], v[60:63]
    v_accvgpr_read_b32 v16, a253
    s_waitcnt lgkmcnt(10)
    ds_write_b128 v19, a[76:79] offset:53760
    v_mfma_f32_16x16x32_bf16 v[64:67], v[212:215], v[144:147], v[64:67]
    v_add_f32 v232, v232, v238
    v_add_f32 v233, v233, v239
    v_mfma_f32_16x16x32_bf16 v[68:71], v[212:215], v[148:151], v[68:71]
    v_rcp_f32 v238, v232
    v_rcp_f32 v239, v233
    v_mfma_f32_16x16x32_bf16 v[72:75], v[216:219], v[136:139], v[72:75]
    v_cmp_nge_f32 s[46:47], s62, v232
    ds_write_b32 v252, v238
    v_mfma_f32_16x16x32_bf16 v[76:79], v[216:219], v[140:143], v[76:79]
    ds_write_b32 v252, v239 offset:64
    ds_read_b128 v[168:171], v228
    v_mfma_f32_16x16x32_bf16 v[80:83], v[216:219], v[144:147], v[80:83]
    ds_read_b128 v[172:175], v228 offset:64
    ds_read_b128 v[176:179], v228 offset:128
    v_mfma_f32_16x16x32_bf16 v[84:87], v[216:219], v[148:151], v[84:87]
    ds_read_b128 v[180:183], v228 offset:192
    ds_read_b128 v[184:187], v228 offset:256
    v_mfma_f32_16x16x32_bf16 v[88:91], v[220:223], v[136:139], v[88:91]
    v_cmp_nge_f32 vcc, s62, v233
    ds_read_b128 v[152:155], v20 offset:16896
    v_mfma_f32_16x16x32_bf16 v[92:95], v[220:223], v[140:143], v[92:95]
    ds_read_b128 v[156:159], v20 offset:17920
    ds_read_b128 v[160:163], v20 offset:18944
    v_mfma_f32_16x16x32_bf16 v[96:99], v[220:223], v[144:147], v[96:99]
    ds_read_b128 v[164:167], v20 offset:19968
    v_mfma_f32_16x16x32_bf16 v[100:103], v[220:223], v[148:151], v[100:103]
    s_or_b64 s[46:47], s[46:47], vcc
    ds_read_b128 v[136:139], v20 offset:33792
    ds_read_b128 v[140:143], v20 offset:34816
    ds_read_b128 v[144:147], v20 offset:35840
    ds_read_b128 v[148:151], v20 offset:36864
    s_cselect_b32 s46, 1, 0
    s_andn2_b32 s46, s46, s41
    s_or_b32 s46, s46, s51
    v_mov_b32 v18, s46
    ds_write_b32 v17, v18
    s_waitcnt lgkmcnt(15)
    v_pk_add_f32 v[24:25], v[24:25], v[104:105]
    v_pk_add_f32 v[26:27], v[26:27], v[106:107]
    v_pk_add_f32 v[28:29], v[28:29], v[108:109]
    v_pk_add_f32 v[30:31], v[30:31], v[110:111]
    v_pk_add_f32 v[40:41], v[40:41], v[120:121]
    v_pk_add_f32 v[42:43], v[42:43], v[122:123]
    v_pk_add_f32 v[44:45], v[44:45], v[124:125]
    v_pk_add_f32 v[46:47], v[46:47], v[126:127]
    s_waitcnt lgkmcnt(13)
    v_pk_mul_f32 v[24:25], v[24:25], v[168:169]
    v_pk_mul_f32 v[26:27], v[26:27], v[170:171]
    v_pk_mul_f32 v[28:29], v[28:29], v[168:169]
    v_pk_mul_f32 v[30:31], v[30:31], v[170:171]
    v_cvt_pk_bf16_f32 v24, v24, v25
    v_cvt_pk_bf16_f32 v25, v26, v27
    v_cvt_pk_bf16_f32 v26, v28, v29
    v_cvt_pk_bf16_f32 v27, v30, v31
    v_or_b32 v24, 1, v24
    v_or_b32 v26, 1, v26
    buffer_store_dwordx4 v[24:27], v229, s[24:27], 0 offen sc1
    ds_write_b128 v230, v[24:27]
    s_barrier
    ds_read_b128 v[192:195], v20 offset:50688
    ds_read_b128 v[196:199], v20 offset:51712
    ds_read_b128 v[200:203], v20 offset:52736
    ds_read_b128 v[204:207], v20 offset:53760
    s_waitcnt lgkmcnt(15)
    v_pk_mul_f32 v[40:41], v[40:41], v[172:173]
    v_pk_mul_f32 v[42:43], v[42:43], v[174:175]
    v_pk_mul_f32 v[44:45], v[44:45], v[172:173]
    v_pk_mul_f32 v[46:47], v[46:47], v[174:175]
    v_cvt_pk_bf16_f32 v40, v40, v41
    v_cvt_pk_bf16_f32 v41, v42, v43
    v_cvt_pk_bf16_f32 v42, v44, v45
    v_cvt_pk_bf16_f32 v43, v46, v47
    v_or_b32 v40, 1, v40
    v_or_b32 v42, 1, v42
    buffer_store_dwordx4 v[40:43], v229, s[24:27], 0 offen offset:1024 sc1
    ds_write_b128 v230, v[40:43] offset:2048
    s_waitcnt lgkmcnt(13)
    v_pk_add_f32 v[56:57], v[56:57], v[152:153]
    v_pk_add_f32 v[58:59], v[58:59], v[154:155]
    v_pk_add_f32 v[60:61], v[60:61], v[156:157]
    v_pk_add_f32 v[62:63], v[62:63], v[158:159]
    v_pk_mul_f32 v[56:57], v[56:57], v[176:177]
    v_pk_mul_f32 v[58:59], v[58:59], v[178:179]
    v_pk_mul_f32 v[60:61], v[60:61], v[176:177]
    v_pk_mul_f32 v[62:63], v[62:63], v[178:179]
    v_cvt_pk_bf16_f32 v56, v56, v57
    v_cvt_pk_bf16_f32 v57, v58, v59
    v_cvt_pk_bf16_f32 v58, v60, v61
    v_cvt_pk_bf16_f32 v59, v62, v63
    v_or_b32 v56, 1, v56
    v_or_b32 v58, 1, v58
    buffer_store_dwordx4 v[56:59], v229, s[24:27], 0 offen offset:2048 sc1
    ds_write_b128 v230, v[56:59] offset:16896
    s_waitcnt lgkmcnt(10)
    v_pk_add_f32 v[72:73], v[72:73], v[136:137]
    v_pk_add_f32 v[74:75], v[74:75], v[138:139]
    v_pk_add_f32 v[76:77], v[76:77], v[140:141]
    v_pk_add_f32 v[78:79], v[78:79], v[142:143]
    v_pk_mul_f32 v[72:73], v[72:73], v[180:181]
    v_pk_mul_f32 v[74:75], v[74:75], v[182:183]
    v_pk_mul_f32 v[76:77], v[76:77], v[180:181]
    v_pk_mul_f32 v[78:79], v[78:79], v[182:183]
    v_cvt_pk_bf16_f32 v72, v72, v73
    v_cvt_pk_bf16_f32 v73, v74, v75
    v_cvt_pk_bf16_f32 v74, v76, v77
    v_cvt_pk_bf16_f32 v75, v78, v79
    v_or_b32 v72, 1, v72
    v_or_b32 v74, 1, v74
    buffer_store_dwordx4 v[72:75], v229, s[24:27], 0 offen offset:3072 sc1
    ds_write_b128 v230, v[72:75] offset:18944
    s_waitcnt lgkmcnt(5)
    v_pk_add_f32 v[88:89], v[88:89], v[192:193]
    v_pk_add_f32 v[90:91], v[90:91], v[194:195]
    v_pk_add_f32 v[92:93], v[92:93], v[196:197]
    v_pk_add_f32 v[94:95], v[94:95], v[198:199]
    v_pk_mul_f32 v[88:89], v[88:89], v[184:185]
    v_pk_mul_f32 v[90:91], v[90:91], v[186:187]
    v_pk_mul_f32 v[92:93], v[92:93], v[184:185]
    v_pk_mul_f32 v[94:95], v[94:95], v[186:187]
    v_cvt_pk_bf16_f32 v88, v88, v89
    v_cvt_pk_bf16_f32 v89, v90, v91
    v_cvt_pk_bf16_f32 v90, v92, v93
    v_cvt_pk_bf16_f32 v91, v94, v95
    v_or_b32 v88, 1, v88
    v_or_b32 v90, 1, v90
    buffer_store_dwordx4 v[88:91], v229, s[24:27], s49 offen sc1
    ds_write_b128 v230, v[88:91] offset:33792
    v_pk_add_f32 v[32:33], v[32:33], v[112:113]
    v_pk_add_f32 v[34:35], v[34:35], v[114:115]
    v_pk_add_f32 v[36:37], v[36:37], v[116:117]
    v_pk_add_f32 v[38:39], v[38:39], v[118:119]
    v_pk_mul_f32 v[32:33], v[32:33], v[168:169]
    v_pk_mul_f32 v[34:35], v[34:35], v[170:171]
    v_pk_mul_f32 v[36:37], v[36:37], v[168:169]
    v_pk_mul_f32 v[38:39], v[38:39], v[170:171]
    v_cvt_pk_bf16_f32 v32, v32, v33
    v_cvt_pk_bf16_f32 v33, v34, v35
    v_cvt_pk_bf16_f32 v34, v36, v37
    v_cvt_pk_bf16_f32 v35, v38, v39
    v_or_b32 v32, 1, v32
    v_or_b32 v34, 1, v34
    buffer_store_dwordx4 v[32:35], v229, s[24:27], s49 offen offset:1024 sc1
    ds_write_b128 v230, v[32:35] offset:1024
    v_pk_add_f32 v[48:49], v[48:49], v[128:129]
    v_pk_add_f32 v[50:51], v[50:51], v[130:131]
    v_pk_add_f32 v[52:53], v[52:53], v[132:133]
    v_pk_add_f32 v[54:55], v[54:55], v[134:135]
    v_pk_mul_f32 v[48:49], v[48:49], v[172:173]
    v_pk_mul_f32 v[50:51], v[50:51], v[174:175]
    v_pk_mul_f32 v[52:53], v[52:53], v[172:173]
    v_pk_mul_f32 v[54:55], v[54:55], v[174:175]
    v_cvt_pk_bf16_f32 v48, v48, v49
    v_cvt_pk_bf16_f32 v49, v50, v51
    v_cvt_pk_bf16_f32 v50, v52, v53
    v_cvt_pk_bf16_f32 v51, v54, v55
    v_or_b32 v48, 1, v48
    v_or_b32 v50, 1, v50
    buffer_store_dwordx4 v[48:51], v229, s[24:27], s49 offen offset:2048 sc1
    ds_write_b128 v230, v[48:51] offset:3072
    v_pk_add_f32 v[64:65], v[64:65], v[160:161]
    v_pk_add_f32 v[66:67], v[66:67], v[162:163]
    v_pk_add_f32 v[68:69], v[68:69], v[164:165]
    v_pk_add_f32 v[70:71], v[70:71], v[166:167]
    v_pk_mul_f32 v[64:65], v[64:65], v[176:177]
    v_pk_mul_f32 v[66:67], v[66:67], v[178:179]
    v_pk_mul_f32 v[68:69], v[68:69], v[176:177]
    v_pk_mul_f32 v[70:71], v[70:71], v[178:179]
    v_cvt_pk_bf16_f32 v64, v64, v65
    v_cvt_pk_bf16_f32 v65, v66, v67
    v_cvt_pk_bf16_f32 v66, v68, v69
    v_cvt_pk_bf16_f32 v67, v70, v71
    v_or_b32 v64, 1, v64
    v_or_b32 v66, 1, v66
    buffer_store_dwordx4 v[64:67], v229, s[24:27], s49 offen offset:3072 sc1
    ds_write_b128 v230, v[64:67] offset:17920
    v_pk_add_f32 v[80:81], v[80:81], v[144:145]
    v_pk_add_f32 v[82:83], v[82:83], v[146:147]
    v_pk_add_f32 v[84:85], v[84:85], v[148:149]
    v_pk_add_f32 v[86:87], v[86:87], v[150:151]
    v_pk_mul_f32 v[80:81], v[80:81], v[180:181]
    v_pk_mul_f32 v[82:83], v[82:83], v[182:183]
    v_pk_mul_f32 v[84:85], v[84:85], v[180:181]
    v_pk_mul_f32 v[86:87], v[86:87], v[182:183]
    v_cvt_pk_bf16_f32 v80, v80, v81
    v_cvt_pk_bf16_f32 v81, v82, v83
    v_cvt_pk_bf16_f32 v82, v84, v85
    v_cvt_pk_bf16_f32 v83, v86, v87
    v_or_b32 v80, 1, v80
    v_or_b32 v82, 1, v82
    buffer_store_dwordx4 v[80:83], v229, s[24:27], s50 offen sc1
    ds_write_b128 v230, v[80:83] offset:19968
    s_waitcnt lgkmcnt(8)
    v_pk_add_f32 v[96:97], v[96:97], v[200:201]
    v_pk_add_f32 v[98:99], v[98:99], v[202:203]
    v_pk_add_f32 v[100:101], v[100:101], v[204:205]
    v_pk_add_f32 v[102:103], v[102:103], v[206:207]
    v_pk_mul_f32 v[96:97], v[96:97], v[184:185]
    v_pk_mul_f32 v[98:99], v[98:99], v[186:187]
    v_pk_mul_f32 v[100:101], v[100:101], v[184:185]
    v_pk_mul_f32 v[102:103], v[102:103], v[186:187]
    v_cvt_pk_bf16_f32 v96, v96, v97
    v_cvt_pk_bf16_f32 v97, v98, v99
    v_cvt_pk_bf16_f32 v98, v100, v101
    v_cvt_pk_bf16_f32 v99, v102, v103
    v_or_b32 v96, 1, v96
    v_or_b32 v98, 1, v98
    buffer_store_dwordx4 v[96:99], v229, s[24:27], s50 offen offset:1024 sc1
    ds_write_b128 v230, v[96:99] offset:34816
    s_waitcnt lgkmcnt(0)
    s_barrier
    ds_read_b128 v[232:235], v22
    ds_read_b64_tr_b16 a[0:1], v21 offset:12672
    ds_read_b64_tr_b16 a[2:3], v16 offset:12672
    ds_read_b64_tr_b16 a[4:5], v21 offset:14720
    ds_read_b64_tr_b16 a[6:7], v16 offset:14720
    ds_read_b64_tr_b16 a[8:9], v21 offset:29568
    ds_read_b64_tr_b16 a[10:11], v16 offset:29568
    ds_read_b64_tr_b16 a[12:13], v21 offset:31616
    ds_read_b64_tr_b16 a[14:15], v16 offset:31616
    ds_read_b64_tr_b16 a[16:17], v21 offset:46464
    ds_read_b64_tr_b16 a[18:19], v16 offset:46464
    s_waitcnt lgkmcnt(10)
    v_or3_b32 v232, v232, v233, v234
    v_or_b32 v232, v232, v235
    s_mov_b32 s39, 0
    v_readfirstlane_b32 s45, v232
    s_xor_b32 s54, s66, 0x800
    s_cmp_lg_u32 s45, 0
    s_cbranch_scc1 L_notyet
L_oph:
    ds_read_b64_tr_b16 a[20:21], v21 offset:13696
    ds_read_b64_tr_b16 a[22:23], v16 offset:13696
    v_mov_b32 v17, -1
    ds_read_b64_tr_b16 a[24:25], v21 offset:15744
    ds_read_b64_tr_b16 a[26:27], v16 offset:15744
    v_lshlrev_b32 v8, 20, v1
    ds_read_b64_tr_b16 a[28:29], v21 offset:30592
    ds_read_b64_tr_b16 a[30:31], v16 offset:30592
    v_mov_b32 v18, 2
    ds_read_b64_tr_b16 a[32:33], v21 offset:32640
    ds_read_b64_tr_b16 a[34:35], v16 offset:32640
    ds_read_b64_tr_b16 a[36:37], v21 offset:47488
    ds_read_b64_tr_b16 a[38:39], v16 offset:47488
    s_waitcnt lgkmcnt(10)
    v_mfma_f32_16x16x32_bf16 v[104:107], a[160:163], a[0:3], 0
    ds_read_b64_tr_b16 v[184:185], v12
    ds_read_b64_tr_b16 v[186:187], v12 offset:2112
    v_mfma_f32_16x16x32_bf16 v[108:111], a[164:167], a[0:3], 0
    ds_read_b64_tr_b16 v[188:189], v13
    ds_read_b64_tr_b16 v[190:191], v13 offset:2112
    v_mfma_f32_16x16x32_bf16 v[112:115], a[168:171], a[0:3], 0
    ds_read_b64_tr_b16 v[192:193], v14
    ds_read_b64_tr_b16 v[194:195], v14 offset:2112
    v_mfma_f32_16x16x32_bf16 v[116:119], a[172:175], a[0:3], 0
    ds_read_b64_tr_b16 v[196:197], v15
    ds_read_b64_tr_b16 v[198:199], v15 offset:2112
    v_mfma_f32_16x16x32_bf16 v[120:123], a[160:163], a[4:7], 0
    ds_read_b64_tr_b16 a[40:41], v21 offset:4224
    ds_read_b64_tr_b16 a[42:43], v16 offset:4224
    v_mfma_f32_16x16x32_bf16 v[124:127], a[164:167], a[4:7], 0
    ds_read_b64_tr_b16 a[44:45], v21 offset:6272
    ds_read_b64_tr_b16 a[46:47], v16 offset:6272
    v_mfma_f32_16x16x32_bf16 v[128:131], a[168:171], a[4:7], 0
    ds_read_b64_tr_b16 a[48:49], v21 offset:21120
    ds_read_b64_tr_b16 a[50:51], v16 offset:21120
    v_mfma_f32_16x16x32_bf16 v[132:135], a[172:175], a[4:7], 0
    ds_read_b64_tr_b16 a[52:53], v21 offset:23168
    ds_read_b64_tr_b16 a[54:55], v16 offset:23168
    v_mfma_f32_16x16x32_bf16 v[136:139], a[160:163], a[8:11], 0
    ds_read_b64_tr_b16 a[56:57], v21 offset:38016
    ds_read_b64_tr_b16 a[58:59], v16 offset:38016
    v_mfma_f32_16x16x32_bf16 v[140:143], a[164:167], a[8:11], 0
    ds_read_b64_tr_b16 a[60:61], v21 offset:5248
    ds_read_b64_tr_b16 a[62:63], v16 offset:5248
    v_mfma_f32_16x16x32_bf16 v[144:147], a[168:171], a[8:11], 0
    ds_read_b64_tr_b16 a[64:65], v21 offset:7296
    ds_read_b64_tr_b16 a[66:67], v16 offset:7296
    v_mfma_f32_16x16x32_bf16 v[148:151], a[172:175], a[8:11], 0
    ds_read_b64_tr_b16 a[68:69], v21 offset:22144
    ds_read_b64_tr_b16 a[70:71], v16 offset:22144
    v_mfma_f32_16x16x32_bf16 v[152:155], a[160:163], a[12:15], 0
    ds_read_b64_tr_b16 a[72:73], v21 offset:24192
    ds_read_b64_tr_b16 a[74:75], v16 offset:24192
    v_mfma_f32_16x16x32_bf16 v[156:159], a[164:167], a[12:15], 0
    ds_read_b64_tr_b16 a[76:77], v21 offset:39040
    ds_read_b64_tr_b16 a[78:79], v16 offset:39040
    v_mfma_f32_16x16x32_bf16 v[160:163], a[168:171], a[12:15], 0
    ds_read_b64_tr_b16 a[80:81], v21 offset:8448
    ds_read_b64_tr_b16 a[82:83], v16 offset:8448
    v_mfma_f32_16x16x32_bf16 v[164:167], a[172:175], a[12:15], 0
    ds_read_b64_tr_b16 a[84:85], v21 offset:10496
    ds_read_b64_tr_b16 a[86:87], v16 offset:10496
    v_mfma_f32_16x16x32_bf16 v[168:171], a[160:163], a[16:19], 0
    ds_read_b64_tr_b16 a[88:89], v21 offset:25344
    ds_read_b64_tr_b16 a[90:91], v16 offset:25344
    v_mfma_f32_16x16x32_bf16 v[172:175], a[164:167], a[16:19], 0
    ds_read_b64_tr_b16 a[92:93], v21 offset:27392
    ds_read_b64_tr_b16 a[94:95], v16 offset:27392
    v_mfma_f32_16x16x32_bf16 v[176:179], a[168:171], a[16:19], 0
    ds_read_b64_tr_b16 a[96:97], v21 offset:42240
    ds_read_b64_tr_b16 a[98:99], v16 offset:42240
    v_mfma_f32_16x16x32_bf16 v[180:183], a[172:175], a[16:19], 0
    ds_read_b64_tr_b16 a[100:101], v21 offset:9472
    ds_read_b64_tr_b16 a[102:103], v16 offset:9472
    s_waitcnt lgkmcnt(15)
    v_mfma_f32_16x16x32_bf16 v[104:107], a[176:179], a[20:23], v[104:107]
    s_add_u32 m0, s40, 0x1ce00
    s_add_u32 s80, s53, 0
    s_mov_b32 s3, 0
    v_mfma_f32_16x16x32_bf16 v[108:111], a[180:183], a[20:23], v[108:111]
    buffer_load_dwordx4 v2, s[20:23], s80 offen lds
    s_mov_b32 s48, 0
    v_mfma_f32_16x16x32_bf16 v[112:115], a[184:187], a[20:23], v[112:115]
    ds_read_b64_tr_b16 v[200:201], v12 offset:16896
    ds_read_b64_tr_b16 v[202:203], v12 offset:19008
    v_mfma_f32_16x16x32_bf16 v[116:119], a[188:191], a[20:23], v[116:119]
    ds_read_b64_tr_b16 v[204:205], v13 offset:16896
    ds_read_b64_tr_b16 v[206:207], v13 offset:19008
    v_mfma_f32_16x16x32_bf16 v[120:123], a[176:179], a[24:27], v[120:123]
    ds_read_b64_tr_b16 v[208:209], v14 offset:16896
    ds_read_b64_tr_b16 v[210:211], v14 offset:19008
    v_mfma_f32_16x16x32_bf16 v[124:127], a[180:183], a[24:27], v[124:127]
    buffer_load_dwordx4 v3, s[20:23], s80 offen offset:1056 lds
    s_lshl_b32 s45, s35, 1
    v_mfma_f32_16x16x32_bf16 v[128:131], a[184:187], a[24:27], v[128:131]
    ds_read_b64_tr_b16 v[212:213], v15 offset:16896
    ds_read_b64_tr_b16 v[214:215], v15 offset:19008
    v_mfma_f32_16x16x32_bf16 v[132:135], a[188:191], a[24:27], v[132:135]
    ds_read_b64_tr_b16 a[104:105], v21 offset:11520
    ds_read_b64_tr_b16 a[106:107], v16 offset:11520
    v_mfma_f32_16x16x32_bf16 v[136:139], a[176:179], a[28:31], v[136:139]
    ds_read_b64_tr_b16 a[108:109], v21 offset:26368
    ds_read_b64_tr_b16 a[110:111], v16 offset:26368
    v_mfma_f32_16x16x32_bf16 v[140:143], a[180:183], a[28:31], v[140:143]
    buffer_load_dwordx4 v4, s[20:23], s80 offen offset:2112 lds
    s_sub_u32 s45, 1, s45
    v_mfma_f32_16x16x32_bf16 v[144:147], a[184:187], a[28:31], v[144:147]
    ds_read_b64_tr_b16 a[112:113], v21 offset:28416
    ds_read_b64_tr_b16 a[114:115], v16 offset:28416
    v_mfma_f32_16x16x32_bf16 v[148:151], a[188:191], a[28:31], v[148:151]
    ds_read_b64_tr_b16 a[116:117], v21 offset:43264
    ds_read_b64_tr_b16 a[118:119], v16 offset:43264
    v_mfma_f32_16x16x32_bf16 v[152:155], a[176:179], a[32:35], v[152:155]
    ds_read_b64_tr_b16 a[120:121], v21
    ds_read_b64_tr_b16 a[122:123], v16
    v_mfma_f32_16x16x32_bf16 v[156:159], a[180:183], a[32:35], v[156:159]
    buffer_load_dwordx4 v5, s[20:23], s80 offen offset:3168 lds
    s_mul_i32 s45, s45, 0x14000
    v_mfma_f32_16x16x32_bf16 v[160:163], a[184:187], a[32:35], v[160:163]
    ds_read_b64_tr_b16 a[124:125], v21 offset:2048
    ds_read_b64_tr_b16 a[126:127], v16 offset:2048
    v_mfma_f32_16x16x32_bf16 v[164:167], a[188:191], a[32:35], v[164:167]
    ds_read_b64_tr_b16 a[128:129], v21 offset:16896
    ds_read_b64_tr_b16 a[130:131], v16 offset:16896
    v_mfma_f32_16x16x32_bf16 v[168:171], a[176:179], a[36:39], v[168:171]
    ds_read_b64_tr_b16 a[132:133], v21 offset:18944
    ds_read_b64_tr_b16 a[134:135], v16 offset:18944
    v_mfma_f32_16x16x32_bf16 v[172:175], a[180:183], a[36:39], v[172:175]
    ds_read_b64_tr_b16 a[136:137], v21 offset:33792
    ds_read_b64_tr_b16 a[138:139], v16 offset:33792
    v_mfma_f32_16x16x32_bf16 v[176:179], a[184:187], a[36:39], v[176:179]
    ds_read_b64_tr_b16 a[140:141], v21 offset:1024
    ds_read_b64_tr_b16 a[142:143], v16 offset:1024
    v_mfma_f32_16x16x32_bf16 v[180:183], a[188:191], a[36:39], v[180:183]
    ds_read_b64_tr_b16 a[144:145], v21 offset:3072
    ds_read_b64_tr_b16 a[146:147], v16 offset:3072
    s_waitcnt lgkmcnt(15)
    s_waitcnt vmcnt(4)
    buffer_store_dword v18, v8, s[24:27], s66 offen sc1
    v_mfma_f32_16x16x32_bf16 v[104:107], a[192:195], a[40:43], v[104:107]
    s_add_u32 m0, s40, 0x21000
    s_add_u32 s80, s53, 0x10000
    v_add_u32 v10, s45, v0
    v_mfma_f32_16x16x32_bf16 v[108:111], a[196:199], a[40:43], v[108:111]
    buffer_load_dwordx4 v2, s[20:23], s80 offen lds
    v_add_u32 v96, 118272, v12
    v_mfma_f32_16x16x32_bf16 v[112:115], a[200:203], a[40:43], v[112:115]
    ds_read_b64_tr_b16 v[60:61], v12 offset:33792
    ds_read_b64_tr_b16 v[62:63], v12 offset:35904
    v_mfma_f32_16x16x32_bf16 v[116:119], a[204:207], a[40:43], v[116:119]
    ds_read_b64_tr_b16 v[64:65], v13 offset:33792
    ds_read_b64_tr_b16 v[66:67], v13 offset:35904
    v_mfma_f32_16x16x32_bf16 v[120:123], a[192:195], a[44:47], v[120:123]
    ds_read_b64_tr_b16 v[68:69], v14 offset:33792
    ds_read_b64_tr_b16 v[70:71], v14 offset:35904
    v_mfma_f32_16x16x32_bf16 v[124:127], a[196:199], a[44:47], v[124:127]
    buffer_load_dwordx4 v3, s[20:23], s80 offen offset:1056 lds
    v_add_u32 v97, 118272, v13
    v_mfma_f32_16x16x32_bf16 v[128:131], a[200:203], a[44:47], v[128:131]
    ds_read_b64_tr_b16 v[72:73], v15 offset:33792
    ds_read_b64_tr_b16 v[74:75], v15 offset:35904
    v_mfma_f32_16x16x32_bf16 v[132:135], a[204:207], a[44:47], v[132:135]
    ds_read_b64_tr_b16 a[148:149], v21 offset:17920
    ds_read_b64_tr_b16 a[150:151], v16 offset:17920
    v_mfma_f32_16x16x32_bf16 v[136:139], a[192:195], a[48:51], v[136:139]
    ds_read_b64_tr_b16 a[152:153], v21 offset:19968
    ds_read_b64_tr_b16 a[154:155], v16 offset:19968
    v_mfma_f32_16x16x32_bf16 v[140:143], a[196:199], a[48:51], v[140:143]
    buffer_load_dwordx4 v4, s[20:23], s80 offen offset:2112 lds
    v_add_u32 v98, 118272, v14
    v_mfma_f32_16x16x32_bf16 v[144:147], a[200:203], a[48:51], v[144:147]
    ds_read_b64_tr_b16 a[156:157], v21 offset:34816
    ds_read_b64_tr_b16 a[158:159], v16 offset:34816
    v_mfma_f32_16x16x32_bf16 v[148:151], a[204:207], a[48:51], v[148:151]
    v_add_u32 v99, 118272, v15
    v_mfma_f32_16x16x32_bf16 v[152:155], a[192:195], a[52:55], v[152:155]
    v_mfma_f32_16x16x32_bf16 v[156:159], a[196:199], a[52:55], v[156:159]
    buffer_load_dwordx4 v5, s[20:23], s80 offen offset:3168 lds
    v_mfma_f32_16x16x32_bf16 v[160:163], a[200:203], a[52:55], v[160:163]
    v_mfma_f32_16x16x32_bf16 v[164:167], a[204:207], a[52:55], v[164:167]
    v_mfma_f32_16x16x32_bf16 v[168:171], a[192:195], a[56:59], v[168:171]
    v_mfma_f32_16x16x32_bf16 v[172:175], a[196:199], a[56:59], v[172:175]
    s_waitcnt lgkmcnt(0)
    s_barrier
    v_mfma_f32_16x16x32_bf16 v[176:179], a[200:203], a[56:59], v[176:179]
    v_mfma_f32_16x16x32_bf16 v[180:183], a[204:207], a[56:59], v[180:183]
    s_buffer_load_dword s3, s[24:27], s54 glc
    v_mfma_f32_16x16x32_bf16 v[104:107], a[208:211], a[60:63], v[104:107]
    s_add_u32 m0, s40, 0
    s_add_u32 s80, s53, 0x20000
    v_mfma_f32_16x16x32_bf16 v[108:111], a[212:215], a[60:63], v[108:111]
    buffer_load_dwordx4 v2, s[20:23], s80 offen lds
    v_mfma_f32_16x16x32_bf16 v[112:115], a[216:219], a[60:63], v[112:115]
    ds_read_b64_tr_b16 v[76:77], v12 offset:50688
    ds_read_b64_tr_b16 v[78:79], v12 offset:52800
    v_mfma_f32_16x16x32_bf16 v[116:119], a[220:223], a[60:63], v[116:119]
    buffer_load_dwordx4 v3, s[20:23], s80 offen offset:1056 lds
    v_mfma_f32_16x16x32_bf16 v[120:123], a[208:211], a[64:67], v[120:123]
    ds_read_b64_tr_b16 v[80:81], v13 offset:50688
    ds_read_b64_tr_b16 v[82:83], v13 offset:52800
    v_mfma_f32_16x16x32_bf16 v[124:127], a[212:215], a[64:67], v[124:127]
    buffer_load_dwordx4 v4, s[20:23], s80 offen offset:2112 lds
    v_mfma_f32_16x16x32_bf16 v[128:131], a[216:219], a[64:67], v[128:131]
    ds_read_b64_tr_b16 v[84:85], v14 offset:50688
    ds_read_b64_tr_b16 v[86:87], v14 offset:52800
    v_mfma_f32_16x16x32_bf16 v[132:135], a[220:223], a[64:67], v[132:135]
    buffer_load_dwordx4 v5, s[20:23], s80 offen offset:3168 lds
    v_mfma_f32_16x16x32_bf16 v[136:139], a[208:211], a[68:71], v[136:139]
    ds_read_b64_tr_b16 v[88:89], v15 offset:50688
    ds_read_b64_tr_b16 v[90:91], v15 offset:52800
    v_mfma_f32_16x16x32_bf16 v[140:143], a[212:215], a[68:71], v[140:143]
    s_add_u32 m0, s40, 0x4200
    s_add_u32 s80, s53, 0x30000
    ds_read_b32 v56, v1
    v_mfma_f32_16x16x32_bf16 v[144:147], a[216:219], a[68:71], v[144:147]
    buffer_load_dwordx4 v2, s[20:23], s80 offen lds
    v_mfma_f32_16x16x32_bf16 v[148:151], a[220:223], a[68:71], v[148:151]
    buffer_load_dwordx4 v3, s[20:23], s80 offen offset:1056 lds
    v_mfma_f32_16x16x32_bf16 v[152:155], a[208:211], a[72:75], v[152:155]
    v_mfma_f32_16x16x32_bf16 v[156:159], a[212:215], a[72:75], v[156:159]
    buffer_load_dwordx4 v4, s[20:23], s80 offen offset:2112 lds
    v_mfma_f32_16x16x32_bf16 v[160:163], a[216:219], a[72:75], v[160:163]
    v_mfma_f32_16x16x32_bf16 v[164:167], a[220:223], a[72:75], v[164:167]
    buffer_load_dwordx4 v5, s[20:23], s80 offen offset:3168 lds
    v_mfma_f32_16x16x32_bf16 v[168:171], a[208:211], a[76:79], v[168:171]
    v_mfma_f32_16x16x32_bf16 v[172:175], a[212:215], a[76:79], v[172:175]
    v_mfma_f32_16x16x32_bf16 v[176:179], a[216:219], a[76:79], v[176:179]
    v_mfma_f32_16x16x32_bf16 v[180:183], a[220:223], a[76:79], v[180:183]
    s_waitcnt lgkmcnt(1)
    s_buffer_load_dword s48, s[24:27], s54 glc
    v_mfma_f32_16x16x32_bf16 v[104:107], v[184:187], a[80:83], v[104:107]
    s_add_u32 m0, s40, 0x8400
    s_add_u32 s80, s53, 0x8000
    v_bfe_u32 v41, v1, 4, 4
    v_mfma_f32_16x16x32_bf16 v[108:111], v[188:191], a[80:83], v[108:111]
    buffer_load_dwordx4 v2, s[20:23], s80 offen lds
    v_lshrrev_b32 v42, 8, v1
    v_mfma_f32_16x16x32_bf16 v[112:115], v[192:195], a[80:83], v[112:115]
    s_mul_i32 s45, s33, 0x28000
    s_lshl_b32 s46, s36, 10
    v_mfma_f32_16x16x32_bf16 v[116:119], v[196:199], a[80:83], v[116:119]
    buffer_load_dwordx4 v3, s[20:23], s80 offen offset:1056 lds
    s_add_u32 s45, s45, s46
    v_mfma_f32_16x16x32_bf16 v[120:123], v[184:187], a[84:87], v[120:123]
    s_add_u32 s12, s68, s45
    s_addc_u32 s13, s69, 0
    v_mfma_f32_16x16x32_bf16 v[124:127], v[188:191], a[84:87], v[124:127]
    buffer_load_dwordx4 v4, s[20:23], s80 offen offset:2112 lds
    s_and_b32 s13, s13, 0xffff
    v_mfma_f32_16x16x32_bf16 v[128:131], v[192:195], a[84:87], v[128:131]
    s_sub_u32 s14, 0x140000, s45
    v_lshrrev_b32 v40, 5, v1
    v_mfma_f32_16x16x32_bf16 v[132:135], v[196:199], a[84:87], v[132:135]
    buffer_load_dwordx4 v5, s[20:23], s80 offen offset:3168 lds
    s_add_u32 m0, s40, 0xc600
    v_mfma_f32_16x16x32_bf16 v[136:139], v[184:187], a[88:91], v[136:139]
    s_add_u32 s80, s53, 0x18000
    v_mul_u32_u24 v37, 128, v1
    v_lshl_add_u32 v37, v40, 24, v37
    v_mfma_f32_16x16x32_bf16 v[140:143], v[188:191], a[88:91], v[140:143]
    buffer_load_dwordx4 v2, s[20:23], s80 offen lds
    v_mov_b32 v40, 1
    v_mfma_f32_16x16x32_bf16 v[144:147], v[192:195], a[88:91], v[144:147]
    v_mul_u32_u24 v32, 163840, v42
    v_lshl_add_u32 v32, v41, 4, v32
    v_mfma_f32_16x16x32_bf16 v[148:151], v[196:199], a[88:91], v[148:151]
    buffer_load_dwordx4 v3, s[20:23], s80 offen offset:1056 lds
    s_lshl_b32 s45, s32, 8
    v_mfma_f32_16x16x32_bf16 v[152:155], v[184:187], a[92:95], v[152:155]
    v_add_u32 v32, s45, v32
    v_and_b32 v33, 1, v42
    v_mfma_f32_16x16x32_bf16 v[156:159], v[188:191], a[92:95], v[156:159]
    buffer_load_dwordx4 v4, s[20:23], s80 offen offset:2112 lds
    v_lshlrev_b32 v33, 5, v33
    v_mfma_f32_16x16x32_bf16 v[160:163], v[192:195], a[92:95], v[160:163]
    v_lshl_add_u32 v33, v41, 11, v33
    s_lshl_b32 s45, s32, 3
    v_mfma_f32_16x16x32_bf16 v[164:167], v[196:199], a[92:95], v[164:167]
    buffer_load_dwordx4 v5, s[20:23], s80 offen offset:3168 lds
    v_add_u32 v33, s45, v33
    v_mfma_f32_16x16x32_bf16 v[168:171], v[184:187], a[96:99], v[168:171]
    v_lshrrev_b32 v42, 1, v42
    v_lshl_add_u32 v34, v42, 28, v33
    v_mfma_f32_16x16x32_bf16 v[172:175], v[188:191], a[96:99], v[172:175]
    s_waitcnt vmcnt(21)
    ds_read_b64_tr_b16 v[44:45], v96
    v_mfma_f32_16x16x32_bf16 v[176:179], v[192:195], a[96:99], v[176:179]
    ds_read_b64_tr_b16 v[46:47], v96 offset:2112
    ds_read_b64_tr_b16 v[48:49], v97
    v_mfma_f32_16x16x32_bf16 v[180:183], v[196:199], a[96:99], v[180:183]
    ds_read_b64_tr_b16 v[50:51], v97 offset:2112
    ds_read_b64_tr_b16 v[52:53], v98
L_pw0:
    s_or_b32 s55, s3, s48
    s_cbranch_scc1 L_pr0
    s_or_b32 s55, s3, s48
    s_cbranch_scc1 L_pr0
    s_or_b32 s55, s3, s48
    s_cbranch_scc1 L_pr0
    s_or_b32 s55, s3, s48
    s_cbranch_scc1 L_pr0
    s_or_b32 s55, s3, s48
    s_cbranch_scc1 L_pr0
    s_or_b32 s55, s3, s48
    s_cbranch_scc1 L_pr0
    s_or_b32 s55, s3, s48
    s_cbranch_scc1 L_pr0
    s_or_b32 s55, s3, s48
    s_cbranch_scc1 L_pr0
    s_waitcnt lgkmcnt(8)
    s_buffer_load_dword s3, s[24:27], s54 glc
    s_add_u32 s39, s39, 0x1000
    s_cbranch_scc0 L_pw0
L_pr0:
    v_mfma_f32_16x16x32_bf16 v[104:107], v[200:203], a[100:103], v[104:107]
    ds_read_b64_tr_b16 v[54:55], v98 offset:2112
    ds_read_b64_tr_b16 v[92:93], v99
    v_mfma_f32_16x16x32_bf16 v[108:111], v[204:207], a[100:103], v[108:111]
    ds_read_b64_tr_b16 v[94:95], v99 offset:2112
    s_add_u32 m0, s40, 0x10800
    v_mfma_f32_16x16x32_bf16 v[112:115], v[208:211], a[100:103], v[112:115]
    buffer_load_dwordx4 v10, s[24:27], 0 offen sc1 lds
    v_lshl_add_u32 v33, v42, 15, v33
    ds_read_b32 v56, v1
    v_mfma_f32_16x16x32_bf16 v[116:119], v[212:215], a[100:103], v[116:119]
    v_and_b32 v42, 1, v41
    v_lshlrev_b32 v42, 4, v42
    ds_read_b32 v56, v1
    v_mfma_f32_16x16x32_bf16 v[120:123], v[200:203], a[104:107], v[120:123]
    v_mov_b32 v43, 16256
    v_lshlrev_b32 v42, v42, v43
    ds_read_b32 v56, v1
    v_mfma_f32_16x16x32_bf16 v[124:127], v[204:207], a[104:107], v[124:127]
    buffer_load_dwordx4 v10, s[24:27], 0 offen offset:1024 sc1 lds
    v_lshrrev_b32 v41, 1, v41
    ds_read_b32 v56, v1
    v_mfma_f32_16x16x32_bf16 v[128:131], v[208:211], a[104:107], v[128:131]
    v_cmp_eq_u32 s[56:57], 0, v41
    v_cmp_eq_u32 s[58:59], 1, v41
    v_mfma_f32_16x16x32_bf16 v[132:135], v[212:215], a[104:107], v[132:135]
    v_cmp_eq_u32 s[60:61], 2, v41
    v_cmp_eq_u32 s[62:63], 3, v41
    v_mfma_f32_16x16x32_bf16 v[136:139], v[200:203], a[108:111], v[136:139]
    s_waitcnt lgkmcnt(4)
    s_add_u32 m0, s40, 0x1ce00
    s_add_u32 s80, s53, 0x28000
    v_mfma_f32_16x16x32_bf16 v[140:143], v[204:207], a[108:111], v[140:143]
    buffer_load_dwordx4 v2, s[20:23], s80 offen lds
    v_cndmask_b32 v24, 0, v42, s[56:57]
    v_mfma_f32_16x16x32_bf16 v[144:147], v[208:211], a[108:111], v[144:147]
    v_cndmask_b32 v25, 0, v42, s[58:59]
    v_cndmask_b32 v26, 0, v42, s[60:61]
    v_mfma_f32_16x16x32_bf16 v[148:151], v[212:215], a[108:111], v[148:151]
    v_cndmask_b32 v27, 0, v42, s[62:63]
    v_cmp_eq_u32 s[56:57], 4, v41
    v_mfma_f32_16x16x32_bf16 v[152:155], v[200:203], a[112:115], v[152:155]
    v_cmp_eq_u32 s[58:59], 5, v41
    v_cmp_eq_u32 s[60:61], 6, v41
    v_mfma_f32_16x16x32_bf16 v[156:159], v[204:207], a[112:115], v[156:159]
    buffer_load_dwordx4 v3, s[20:23], s80 offen offset:1056 lds
    v_cmp_eq_u32 s[62:63], 7, v41
    v_mfma_f32_16x16x32_bf16 v[160:163], v[208:211], a[112:115], v[160:163]
    s_waitcnt vmcnt(20)
    ds_read_b64_tr_b16 a[160:161], v96 offset:16896
    v_mfma_f32_16x16x32_bf16 v[164:167], v[212:215], a[112:115], v[164:167]
    ds_read_b64_tr_b16 a[162:163], v96 offset:19008
    ds_read_b64_tr_b16 a[164:165], v97 offset:16896
    v_mfma_f32_16x16x32_bf16 v[168:171], v[200:203], a[116:119], v[168:171]
    ds_read_b64_tr_b16 a[166:167], v97 offset:19008
    ds_read_b64_tr_b16 a[168:169], v98 offset:16896
    v_mfma_f32_16x16x32_bf16 v[172:175], v[204:207], a[116:119], v[172:175]
    ds_read_b64_tr_b16 a[170:171], v98 offset:19008
    v_cndmask_b32 v28, 0, v42, s[56:57]
    v_mfma_f32_16x16x32_bf16 v[176:179], v[208:211], a[116:119], v[176:179]
    buffer_load_dwordx4 v4, s[20:23], s80 offen offset:2112 lds
    v_cndmask_b32 v29, 0, v42, s[58:59]
    v_mfma_f32_16x16x32_bf16 v[180:183], v[212:215], a[116:119], v[180:183]
    ds_read_b64_tr_b16 a[172:173], v99 offset:16896
    ds_read_b64_tr_b16 a[174:175], v99 offset:19008
    v_mfma_f32_16x16x32_bf16 v[104:107], v[60:63], a[120:123], v[104:107]
    v_cndmask_b32 v30, 0, v42, s[60:61]
    v_cndmask_b32 v31, 0, v42, s[62:63]
    v_mfma_f32_16x16x32_bf16 v[108:111], v[64:67], a[120:123], v[108:111]
    buffer_load_dwordx4 v5, s[20:23], s80 offen offset:3168 lds
    s_mul_i32 s60, s71, 0x800
    v_mfma_f32_16x16x32_bf16 v[112:115], v[68:71], a[120:123], v[112:115]
    s_waitcnt vmcnt(18)
    ds_read_b64_tr_b16 a[176:177], v12
    v_mfma_f32_16x16x32_bf16 v[116:119], v[72:75], a[120:123], v[116:119]
    ds_read_b64_tr_b16 a[178:179], v12 offset:2112
    ds_read_b64_tr_b16 a[180:181], v13
    v_mfma_f32_16x16x32_bf16 v[120:123], v[60:63], a[124:127], v[120:123]
    ds_read_b64_tr_b16 a[182:183], v13 offset:2112
    ds_read_b64_tr_b16 a[184:185], v14
    v_mfma_f32_16x16x32_bf16 v[124:127], v[64:67], a[124:127], v[124:127]
    ds_read_b64_tr_b16 a[186:187], v14 offset:2112
    s_add_u32 m0, s40, 0x14a00
    v_mfma_f32_16x16x32_bf16 v[128:131], v[68:71], a[124:127], v[128:131]
    buffer_load_dwordx4 v10, s[24:27], s49 offen offset:1024 sc1 lds
    s_add_u32 s60, s60, 0x140000
    v_mfma_f32_16x16x32_bf16 v[132:135], v[72:75], a[124:127], v[132:135]
    ds_read_b64_tr_b16 a[188:189], v15
    ds_read_b64_tr_b16 a[190:191], v15 offset:2112
    v_mfma_f32_16x16x32_bf16 v[136:139], v[60:63], a[128:131], v[136:139]
    s_lshr_b32 s45, s71, 3
    s_xor_b32 s45, s45, 1
    v_mfma_f32_16x16x32_bf16 v[140:143], v[64:67], a[128:131], v[140:143]
    buffer_load_dwordx4 v10, s[24:27], s49 offen offset:2048 sc1 lds
    s_mul_i32 s45, s45, 0x14000
    v_mfma_f32_16x16x32_bf16 v[144:147], v[68:71], a[128:131], v[144:147]
    s_and_b32 s46, s71, 7
    s_mul_i32 s46, s46, 0x1400
    v_mfma_f32_16x16x32_bf16 v[148:151], v[72:75], a[128:131], v[148:151]
    s_add_u32 s56, s45, s46
    s_add_u32 s57, s56, 0x1000
    v_mfma_f32_16x16x32_bf16 v[152:155], v[60:63], a[132:135], v[152:155]
    s_waitcnt lgkmcnt(8)
    s_add_u32 m0, s40, 0x21000
    s_add_u32 s80, s53, 0x38000
    v_mfma_f32_16x16x32_bf16 v[156:159], v[64:67], a[132:135], v[156:159]
    buffer_load_dwordx4 v2, s[20:23], s80 offen lds
    s_add_u32 s58, s56, 0xa0000
    v_mfma_f32_16x16x32_bf16 v[160:163], v[68:71], a[132:135], v[160:163]
    s_add_u32 s59, s56, 0xa1000
    s_lshl_b32 s61, s71, 6
    v_mfma_f32_16x16x32_bf16 v[164:167], v[72:75], a[132:135], v[164:167]
    s_add_u32 s62, s61, 0x10000
    s_add_u32 s63, s61, 0x20000
    v_mfma_f32_16x16x32_bf16 v[168:171], v[60:63], a[136:139], v[168:171]
    v_mfma_f32_16x16x32_bf16 v[172:175], v[64:67], a[136:139], v[172:175]
    buffer_load_dwordx4 v3, s[20:23], s80 offen offset:1056 lds
    v_mfma_f32_16x16x32_bf16 v[176:179], v[68:71], a[136:139], v[176:179]
    s_waitcnt vmcnt(18)
    ds_read_b64_tr_b16 a[192:193], v12 offset:16896
    v_mfma_f32_16x16x32_bf16 v[180:183], v[72:75], a[136:139], v[180:183]
    ds_read_b64_tr_b16 a[194:195], v12 offset:19008
    ds_read_b64_tr_b16 a[196:197], v13 offset:16896
    v_mfma_f32_16x16x32_bf16 v[104:107], v[76:79], a[140:143], v[104:107]
    ds_read_b64_tr_b16 a[198:199], v13 offset:19008
    ds_read_b64_tr_b16 a[200:201], v14 offset:16896
    v_mfma_f32_16x16x32_bf16 v[108:111], v[80:83], a[140:143], v[108:111]
    ds_read_b64_tr_b16 a[202:203], v14 offset:19008
    v_mfma_f32_16x16x32_bf16 v[112:115], v[84:87], a[140:143], v[112:115]
    buffer_load_dwordx4 v4, s[20:23], s80 offen offset:2112 lds
    v_mfma_f32_16x16x32_bf16 v[116:119], v[88:91], a[140:143], v[116:119]
    ds_read_b64_tr_b16 a[204:205], v15 offset:16896
    ds_read_b64_tr_b16 a[206:207], v15 offset:19008
    v_mfma_f32_16x16x32_bf16 v[120:123], v[76:79], a[144:147], v[120:123]
    s_waitcnt vmcnt(15)
    ds_read_b64_tr_b16 a[208:209], v12 offset:33792
    v_mfma_f32_16x16x32_bf16 v[124:127], v[80:83], a[144:147], v[124:127]
    ds_read_b64_tr_b16 a[210:211], v12 offset:35904
    ds_read_b64_tr_b16 a[212:213], v13 offset:33792
    v_mfma_f32_16x16x32_bf16 v[128:131], v[84:87], a[144:147], v[128:131]
    ds_read_b64_tr_b16 a[214:215], v13 offset:35904
    ds_read_b64_tr_b16 a[216:217], v14 offset:33792
    v_mfma_f32_16x16x32_bf16 v[132:135], v[88:91], a[144:147], v[132:135]
    ds_read_b64_tr_b16 a[218:219], v14 offset:35904
    v_mfma_f32_16x16x32_bf16 v[136:139], v[76:79], a[148:151], v[136:139]
    buffer_load_dwordx4 v5, s[20:23], s80 offen offset:3168 lds
    v_mfma_f32_16x16x32_bf16 v[140:143], v[80:83], a[148:151], v[140:143]
    ds_read_b64_tr_b16 a[220:221], v15 offset:33792
    ds_read_b64_tr_b16 a[222:223], v15 offset:35904
    s_waitcnt vmcnt(10)
    s_barrier
    v_mfma_f32_16x16x32_bf16 v[144:147], v[84:87], a[148:151], v[144:147]
    s_add_u32 m0, s40, 0x10800
    v_mfma_f32_16x16x32_bf16 v[148:151], v[88:91], a[148:151], v[148:151]
    buffer_load_dwordx4 v10, s[24:27], 0 offen offset:2048 sc1 lds
    v_mfma_f32_16x16x32_bf16 v[152:155], v[76:79], a[152:155], v[152:155]
    ds_read_b64_tr_b16 a[0:1], v21
    ds_read_b64_tr_b16 a[2:3], v16
    v_mfma_f32_16x16x32_bf16 v[156:159], v[80:83], a[152:155], v[156:159]
    ds_read_b64_tr_b16 a[4:5], v21 offset:1024
    ds_read_b64_tr_b16 a[6:7], v16 offset:1024
    v_mfma_f32_16x16x32_bf16 v[160:163], v[84:87], a[152:155], v[160:163]
    s_add_u32 m0, s40, 0x14a00
    v_mfma_f32_16x16x32_bf16 v[164:167], v[88:91], a[152:155], v[164:167]
    buffer_load_dwordx4 v10, s[24:27], s49 offen offset:3072 sc1 lds
    v_mfma_f32_16x16x32_bf16 v[168:171], v[76:79], a[156:159], v[168:171]
    ds_read_b64_tr_b16 a[20:21], v21 offset:8448
    ds_read_b64_tr_b16 a[22:23], v16 offset:8448
    v_mfma_f32_16x16x32_bf16 v[172:175], v[80:83], a[156:159], v[172:175]
    ds_read_b64_tr_b16 a[24:25], v21 offset:9472
    ds_read_b64_tr_b16 a[26:27], v16 offset:9472
    v_mfma_f32_16x16x32_bf16 v[176:179], v[84:87], a[156:159], v[176:179]
    v_mfma_f32_16x16x32_bf16 v[180:183], v[88:91], a[156:159], v[180:183]
    s_waitcnt lgkmcnt(4)
    v_mfma_f32_16x16x32_bf16 v[104:107], v[44:47], a[0:3], v[104:107]
    v_mfma_f32_16x16x32_bf16 v[108:111], v[48:51], a[0:3], v[108:111]
    v_mfma_f32_16x16x32_bf16 v[112:115], v[52:55], a[0:3], v[112:115]
    v_mfma_f32_16x16x32_bf16 v[116:119], v[92:95], a[0:3], v[116:119]
    v_mfma_f32_16x16x32_bf16 v[120:123], v[44:47], a[4:7], v[120:123]
    ds_read_b64_tr_b16 a[40:41], v21 offset:4224
    ds_read_b64_tr_b16 a[42:43], v16 offset:4224
    v_mfma_f32_16x16x32_bf16 v[124:127], v[48:51], a[4:7], v[124:127]
    ds_read_b64_tr_b16 a[44:45], v21 offset:5248
    ds_read_b64_tr_b16 a[46:47], v16 offset:5248
    v_mfma_f32_16x16x32_bf16 v[128:131], v[52:55], a[4:7], v[128:131]
    s_waitcnt vmcnt(14)
    ds_read_b64_tr_b16 v[184:185], v12 offset:50688
    v_mfma_f32_16x16x32_bf16 v[132:135], v[92:95], a[4:7], v[132:135]
    ds_read_b64_tr_b16 v[186:187], v12 offset:52800
    ds_read_b64_tr_b16 v[188:189], v13 offset:50688
    s_waitcnt lgkmcnt(7)
    v_mfma_f32_16x16x32_bf16 v[104:107], a[160:163], a[20:23], v[104:107]
    ds_read_b64_tr_b16 v[190:191], v13 offset:52800
    ds_read_b64_tr_b16 v[192:193], v14 offset:50688
    v_mfma_f32_16x16x32_bf16 v[108:111], a[164:167], a[20:23], v[108:111]
    ds_read_b64_tr_b16 v[194:195], v14 offset:52800
    ds_read_b64_tr_b16 v[196:197], v15 offset:50688
    v_mfma_f32_16x16x32_bf16 v[112:115], a[168:171], a[20:23], v[112:115]
    ds_read_b64_tr_b16 v[198:199], v15 offset:52800
    v_mfma_f32_16x16x32_bf16 v[116:119], a[172:175], a[20:23], v[116:119]
    v_mfma_f32_16x16x32_bf16 v[120:123], a[160:163], a[24:27], v[120:123]
    ds_read_b64_tr_b16 a[60:61], v21 offset:12672
    ds_read_b64_tr_b16 a[62:63], v16 offset:12672
    v_mfma_f32_16x16x32_bf16 v[124:127], a[164:167], a[24:27], v[124:127]
    ds_read_b64_tr_b16 a[64:65], v21 offset:13696
    ds_read_b64_tr_b16 a[66:67], v16 offset:13696
    v_mfma_f32_16x16x32_bf16 v[128:131], a[168:171], a[24:27], v[128:131]
    s_add_u32 m0, s40, 0x10800
    v_mfma_f32_16x16x32_bf16 v[132:135], a[172:175], a[24:27], v[132:135]
    buffer_load_dwordx4 v10, s[24:27], 0 offen offset:3072 sc1 lds
    s_waitcnt vmcnt(9)
    s_waitcnt lgkmcnt(12)
    v_mfma_f32_16x16x32_bf16 v[104:107], a[176:179], a[40:43], v[104:107]
    ds_read_b64_tr_b16 v[200:201], v96
    ds_read_b64_tr_b16 v[202:203], v96 offset:2112
    v_mfma_f32_16x16x32_bf16 v[108:111], a[180:183], a[40:43], v[108:111]
    ds_read_b64_tr_b16 v[204:205], v97
    ds_read_b64_tr_b16 v[206:207], v97 offset:2112
    v_mfma_f32_16x16x32_bf16 v[112:115], a[184:187], a[40:43], v[112:115]
    ds_read_b64_tr_b16 v[208:209], v98
    ds_read_b64_tr_b16 v[210:211], v98 offset:2112
    v_mfma_f32_16x16x32_bf16 v[116:119], a[188:191], a[40:43], v[116:119]
    s_add_u32 m0, s40, 0x18c00
    v_mfma_f32_16x16x32_bf16 v[120:123], a[176:179], a[44:47], v[120:123]
    buffer_load_dwordx4 v10, s[24:27], s50 offen sc1 lds
    v_mfma_f32_16x16x32_bf16 v[124:127], a[180:183], a[44:47], v[124:127]
    ds_read_b64_tr_b16 v[212:213], v99
    ds_read_b64_tr_b16 v[214:215], v99 offset:2112
    s_waitcnt vmcnt(8)
    s_barrier
    v_mfma_f32_16x16x32_bf16 v[128:131], a[184:187], a[44:47], v[128:131]
    ds_read_b64_tr_b16 a[80:81], v21 offset:17920
    ds_read_b64_tr_b16 a[82:83], v16 offset:17920
    v_mfma_f32_16x16x32_bf16 v[132:135], a[188:191], a[44:47], v[132:135]
    ds_read_b64_tr_b16 a[84:85], v21 offset:18944
    ds_read_b64_tr_b16 a[86:87], v16 offset:18944
    s_waitcnt lgkmcnt(12)
    v_mfma_f32_16x16x32_bf16 v[104:107], a[192:195], a[60:63], v[104:107]
    ds_read_b64_tr_b16 a[120:121], v21 offset:22144
    ds_read_b64_tr_b16 a[122:123], v16 offset:22144
    v_mfma_f32_16x16x32_bf16 v[108:111], a[196:199], a[60:63], v[108:111]
    v_mfma_f32_16x16x32_bf16 v[112:115], a[200:203], a[60:63], v[112:115]
    ds_read_b64_tr_b16 a[140:141], v21 offset:30592
    ds_read_b64_tr_b16 a[142:143], v16 offset:30592
    v_mfma_f32_16x16x32_bf16 v[116:119], a[204:207], a[60:63], v[116:119]
    v_mfma_f32_16x16x32_bf16 v[120:123], a[192:195], a[64:67], v[120:123]
    ds_read_b64_tr_b16 a[100:101], v21 offset:26368
    ds_read_b64_tr_b16 a[102:103], v16 offset:26368
    v_mfma_f32_16x16x32_bf16 v[124:127], a[196:199], a[64:67], v[124:127]
    ds_read_b64_tr_b16 a[104:105], v21 offset:27392
    ds_read_b64_tr_b16 a[106:107], v16 offset:27392
    v_mfma_f32_16x16x32_bf16 v[128:131], a[200:203], a[64:67], v[128:131]
    s_waitcnt vmcnt(4)
    ds_read_b64_tr_b16 v[60:61], v96 offset:16896
    v_mfma_f32_16x16x32_bf16 v[132:135], a[204:207], a[64:67], v[132:135]
    ds_read_b64_tr_b16 v[62:63], v96 offset:19008
    ds_read_b64_tr_b16 v[64:65], v97 offset:16896
    s_waitcnt lgkmcnt(11)
    v_mfma_f32_16x16x32_bf16 v[104:107], a[208:211], a[80:83], v[104:107]
    ds_read_b64_tr_b16 v[66:67], v97 offset:19008
    ds_read_b64_tr_b16 a[124:125], v21 offset:23168
    v_mfma_f32_16x16x32_bf16 v[108:111], a[212:215], a[80:83], v[108:111]
    ds_read_b64_tr_b16 a[126:127], v16 offset:23168
    ds_read_b64_tr_b16 v[68:69], v98 offset:16896
    v_mfma_f32_16x16x32_bf16 v[112:115], a[216:219], a[80:83], v[112:115]
    ds_read_b64_tr_b16 v[70:71], v98 offset:19008
    ds_read_b64_tr_b16 v[72:73], v99 offset:16896
    v_mfma_f32_16x16x32_bf16 v[116:119], a[220:223], a[80:83], v[116:119]
    ds_read_b64_tr_b16 v[74:75], v99 offset:19008
    ds_read_b64_tr_b16 a[144:145], v21 offset:31616
    v_mfma_f32_16x16x32_bf16 v[120:123], a[208:211], a[84:87], v[120:123]
    ds_read_b64_tr_b16 a[146:147], v16 offset:31616
    s_add_u32 m0, s40, 0x14a00
    v_mfma_f32_16x16x32_bf16 v[124:127], a[212:215], a[84:87], v[124:127]
    buffer_load_dwordx4 v10, s[24:27], s49 offen sc1 lds
    v_mfma_f32_16x16x32_bf16 v[128:131], a[216:219], a[84:87], v[128:131]
    v_mfma_f32_16x16x32_bf16 v[132:135], a[220:223], a[84:87], v[132:135]
    s_waitcnt lgkmcnt(12)
    v_mfma_f32_16x16x32_bf16 v[104:107], v[184:187], a[100:103], v[104:107]
    s_add_u32 m0, s40, 0x18c00
    v_mfma_f32_16x16x32_bf16 v[108:111], v[188:191], a[100:103], v[108:111]
    buffer_load_dwordx4 v10, s[24:27], s50 offen offset:1024 sc1 lds
    v_mfma_f32_16x16x32_bf16 v[112:115], v[192:195], a[100:103], v[112:115]
    v_mfma_f32_16x16x32_bf16 v[116:119], v[196:199], a[100:103], v[116:119]
    s_waitcnt vmcnt(4)
    s_barrier
    v_mfma_f32_16x16x32_bf16 v[120:123], v[184:187], a[104:107], v[120:123]
    ds_read_b64_tr_b16 a[8:9], v21 offset:2048
    ds_read_b64_tr_b16 a[10:11], v16 offset:2048
    v_mfma_f32_16x16x32_bf16 v[124:127], v[188:191], a[104:107], v[124:127]
    v_mfma_f32_16x16x32_bf16 v[128:131], v[192:195], a[104:107], v[128:131]
    ds_read_b64_tr_b16 a[28:29], v21 offset:10496
    ds_read_b64_tr_b16 a[30:31], v16 offset:10496
    v_mfma_f32_16x16x32_bf16 v[132:135], v[196:199], a[104:107], v[132:135]
    s_waitcnt lgkmcnt(6)
    v_mfma_f32_16x16x32_bf16 v[104:107], v[200:203], a[120:123], v[104:107]
    ds_read_b64_tr_b16 a[48:49], v21 offset:6272
    ds_read_b64_tr_b16 a[50:51], v16 offset:6272
    v_mfma_f32_16x16x32_bf16 v[104:107], v[60:63], a[140:143], v[104:107]
    v_mfma_f32_16x16x32_bf16 v[108:111], v[64:67], a[140:143], v[108:111]
    ds_read_b64_tr_b16 a[68:69], v21 offset:14720
    ds_read_b64_tr_b16 a[70:71], v16 offset:14720
    v_mfma_f32_16x16x32_bf16 v[108:111], v[204:207], a[120:123], v[108:111]
    v_mfma_f32_16x16x32_bf16 v[112:115], v[208:211], a[120:123], v[112:115]
    ds_read_b64_tr_b16 a[88:89], v21 offset:19968
    ds_read_b64_tr_b16 a[90:91], v16 offset:19968
    v_mfma_f32_16x16x32_bf16 v[112:115], v[68:71], a[140:143], v[112:115]
    v_cvt_pk_bf16_f32 v216, v104, v105
    v_cvt_pk_bf16_f32 v217, v106, v107
    v_mfma_f32_16x16x32_bf16 v[116:119], v[72:75], a[140:143], v[116:119]
    ds_read_b64_tr_b16 a[108:109], v21 offset:28416
    ds_read_b64_tr_b16 a[110:111], v16 offset:28416
    v_mfma_f32_16x16x32_bf16 v[116:119], v[212:215], a[120:123], v[116:119]
    v_cvt_pk_bf16_f32 v218, v108, v109
    v_cvt_pk_bf16_f32 v219, v110, v111
    s_waitcnt lgkmcnt(12)
    v_mfma_f32_16x16x32_bf16 v[120:123], v[200:203], a[124:127], v[120:123]
    ds_read_b64_tr_b16 a[128:129], v21 offset:24192
    ds_read_b64_tr_b16 a[130:131], v16 offset:24192
    v_mfma_f32_16x16x32_bf16 v[120:123], v[60:63], a[144:147], v[120:123]
    v_and_b32 v216, -2, v216
    v_and_b32 v218, -2, v218
    v_mfma_f32_16x16x32_bf16 v[124:127], v[64:67], a[144:147], v[124:127]
    ds_read_b64_tr_b16 a[148:149], v21 offset:32640
    ds_read_b64_tr_b16 a[150:151], v16 offset:32640
    v_mfma_f32_16x16x32_bf16 v[124:127], v[204:207], a[124:127], v[124:127]
    buffer_store_dwordx4 v[216:219], v10, s[24:27], 0 offen sc1
    v_mfma_f32_16x16x32_bf16 v[128:131], v[208:211], a[124:127], v[128:131]
    v_cvt_pk_bf16_f32 v220, v112, v113
    v_cvt_pk_bf16_f32 v221, v114, v115
    v_mfma_f32_16x16x32_bf16 v[128:131], v[68:71], a[144:147], v[128:131]
    v_mfma_f32_16x16x32_bf16 v[132:135], v[72:75], a[144:147], v[132:135]
    v_mfma_f32_16x16x32_bf16 v[132:135], v[212:215], a[124:127], v[132:135]
    v_cvt_pk_bf16_f32 v222, v116, v117
    v_cvt_pk_bf16_f32 v223, v118, v119
    s_waitcnt lgkmcnt(0)
    v_mfma_f32_16x16x32_bf16 v[136:139], v[44:47], a[8:11], v[136:139]
    v_and_b32 v220, -2, v220
    v_and_b32 v222, -2, v222
    v_mfma_f32_16x16x32_bf16 v[136:139], a[160:163], a[28:31], v[136:139]
    buffer_store_dwordx4 v[220:223], v10, s[24:27], s49 offen offset:1024 sc1
    v_mfma_f32_16x16x32_bf16 v[136:139], a[176:179], a[48:51], v[136:139]
    v_cvt_pk_bf16_f32 v224, v120, v121
    v_cvt_pk_bf16_f32 v225, v122, v123
    v_mfma_f32_16x16x32_bf16 v[136:139], a[192:195], a[68:71], v[136:139]
    v_mfma_f32_16x16x32_bf16 v[136:139], a[208:211], a[88:91], v[136:139]
    v_mfma_f32_16x16x32_bf16 v[136:139], v[184:187], a[108:111], v[136:139]
    v_mfma_f32_16x16x32_bf16 v[136:139], v[200:203], a[128:131], v[136:139]
    v_mfma_f32_16x16x32_bf16 v[136:139], v[60:63], a[148:151], v[136:139]
    v_cvt_pk_bf16_f32 v226, v124, v125
    v_cvt_pk_bf16_f32 v227, v126, v127
    v_mfma_f32_16x16x32_bf16 v[140:143], v[64:67], a[148:151], v[140:143]
    v_and_b32 v224, -2, v224
    v_and_b32 v226, -2, v226
    v_mfma_f32_16x16x32_bf16 v[140:143], v[204:207], a[128:131], v[140:143]
    buffer_store_dwordx4 v[224:227], v10, s[24:27], 0 offen offset:1024 sc1
    s_waitcnt vmcnt(5)
    s_barrier
    v_mfma_f32_16x16x32_bf16 v[140:143], v[188:191], a[108:111], v[140:143]
    ds_read_b64_tr_b16 a[12:13], v21 offset:3072
    ds_read_b64_tr_b16 a[14:15], v16 offset:3072
    v_mfma_f32_16x16x32_bf16 v[140:143], a[212:215], a[88:91], v[140:143]
    v_cvt_pk_bf16_f32 v228, v128, v129
    v_cvt_pk_bf16_f32 v229, v130, v131
    v_mfma_f32_16x16x32_bf16 v[140:143], a[196:199], a[68:71], v[140:143]
    ds_read_b64_tr_b16 a[32:33], v21 offset:11520
    ds_read_b64_tr_b16 a[34:35], v16 offset:11520
    v_mfma_f32_16x16x32_bf16 v[140:143], a[180:183], a[48:51], v[140:143]
    v_mfma_f32_16x16x32_bf16 v[140:143], a[164:167], a[28:31], v[140:143]
    ds_read_b64_tr_b16 a[52:53], v21 offset:7296
    ds_read_b64_tr_b16 a[54:55], v16 offset:7296
    v_mfma_f32_16x16x32_bf16 v[140:143], v[48:51], a[8:11], v[140:143]
    v_cvt_pk_bf16_f32 v230, v132, v133
    v_cvt_pk_bf16_f32 v231, v134, v135
    v_mfma_f32_16x16x32_bf16 v[144:147], v[52:55], a[8:11], v[144:147]
    ds_read_b64_tr_b16 a[72:73], v21 offset:15744
    ds_read_b64_tr_b16 a[74:75], v16 offset:15744
    v_mfma_f32_16x16x32_bf16 v[144:147], a[168:171], a[28:31], v[144:147]
    v_and_b32 v228, -2, v228
    v_and_b32 v230, -2, v230
    v_mfma_f32_16x16x32_bf16 v[144:147], a[184:187], a[48:51], v[144:147]
    ds_read_b64_tr_b16 a[92:93], v21 offset:33792
    ds_read_b64_tr_b16 a[94:95], v16 offset:33792
    v_mfma_f32_16x16x32_bf16 v[144:147], a[200:203], a[68:71], v[144:147]
    buffer_store_dwordx4 v[228:231], v10, s[24:27], s49 offen offset:2048 sc1
    v_mfma_f32_16x16x32_bf16 v[144:147], a[216:219], a[88:91], v[144:147]
    ds_read_b64_tr_b16 a[112:113], v21 offset:42240
    ds_read_b64_tr_b16 a[114:115], v16 offset:42240
    v_mfma_f32_16x16x32_bf16 v[144:147], v[192:195], a[108:111], v[144:147]
    s_mov_b32 s39, 0
    s_mov_b64 s[52:53], 0
    v_mfma_f32_16x16x32_bf16 v[144:147], v[208:211], a[128:131], v[144:147]
    ds_read_b64_tr_b16 a[132:133], v21 offset:38016
    ds_read_b64_tr_b16 a[134:135], v16 offset:38016
    v_mfma_f32_16x16x32_bf16 v[144:147], v[68:71], a[148:151], v[144:147]
    s_mov_b64 s[54:55], 0
    v_cvt_pk_bf16_f32 v232, v136, v137
    v_mfma_f32_16x16x32_bf16 v[148:151], v[72:75], a[148:151], v[148:151]
    ds_read_b64_tr_b16 a[152:153], v21 offset:46464
    ds_read_b64_tr_b16 a[154:155], v16 offset:46464
    v_mfma_f32_16x16x32_bf16 v[148:151], v[212:215], a[128:131], v[148:151]
    v_cvt_pk_bf16_f32 v233, v138, v139
    v_cvt_pk_bf16_f32 v234, v140, v141
    v_mfma_f32_16x16x32_bf16 v[148:151], v[196:199], a[108:111], v[148:151]
    v_cvt_pk_bf16_f32 v235, v142, v143
    v_and_b32 v232, -2, v232
    v_mfma_f32_16x16x32_bf16 v[148:151], a[220:223], a[88:91], v[148:151]
    v_and_b32 v234, -2, v234
    v_mfma_f32_16x16x32_bf16 v[148:151], a[204:207], a[68:71], v[148:151]
    buffer_store_dwordx4 v[232:235], v10, s[24:27], 0 offen offset:2048 sc1
    v_mfma_f32_16x16x32_bf16 v[148:151], a[188:191], a[48:51], v[148:151]
    v_cvt_pk_bf16_f32 v236, v144, v145
    v_cvt_pk_bf16_f32 v237, v146, v147
    v_mfma_f32_16x16x32_bf16 v[148:151], a[172:175], a[28:31], v[148:151]
    v_mfma_f32_16x16x32_bf16 v[148:151], v[92:95], a[8:11], v[148:151]
    s_waitcnt lgkmcnt(0)
    v_mfma_f32_16x16x32_bf16 v[152:155], v[44:47], a[12:15], v[152:155]
    v_mfma_f32_16x16x32_bf16 v[152:155], a[160:163], a[32:35], v[152:155]
    v_mfma_f32_16x16x32_bf16 v[152:155], a[176:179], a[52:55], v[152:155]
    v_mfma_f32_16x16x32_bf16 v[152:155], a[192:195], a[72:75], v[152:155]
    v_cvt_pk_bf16_f32 v238, v148, v149
    v_cvt_pk_bf16_f32 v239, v150, v151
    v_mfma_f32_16x16x32_bf16 v[152:155], a[208:211], a[92:95], v[152:155]
    v_and_b32 v236, -2, v236
    v_and_b32 v238, -2, v238
    v_mfma_f32_16x16x32_bf16 v[152:155], v[184:187], a[112:115], v[152:155]
    buffer_store_dwordx4 v[236:239], v10, s[24:27], s49 offen offset:3072 sc1
    s_waitcnt vmcnt(6)
    s_barrier
    v_mfma_f32_16x16x32_bf16 v[152:155], v[200:203], a[132:135], v[152:155]
    v_mfma_f32_16x16x32_bf16 v[152:155], v[60:63], a[152:155], v[152:155]
    v_mfma_f32_16x16x32_bf16 v[156:159], v[64:67], a[152:155], v[156:159]
    ds_read_b64_tr_b16 a[16:17], v21 offset:16896
    ds_read_b64_tr_b16 a[18:19], v16 offset:16896
    v_mfma_f32_16x16x32_bf16 v[156:159], v[204:207], a[132:135], v[156:159]
    v_mfma_f32_16x16x32_bf16 v[156:159], v[188:191], a[112:115], v[156:159]
    ds_read_b64_tr_b16 a[36:37], v21 offset:25344
    ds_read_b64_tr_b16 a[38:39], v16 offset:25344
    v_mfma_f32_16x16x32_bf16 v[156:159], a[212:215], a[92:95], v[156:159]
    v_mfma_f32_16x16x32_bf16 v[156:159], a[196:199], a[72:75], v[156:159]
    ds_read_b64_tr_b16 a[56:57], v21 offset:21120
    ds_read_b64_tr_b16 a[58:59], v16 offset:21120
    v_mfma_f32_16x16x32_bf16 v[156:159], a[180:183], a[52:55], v[156:159]
    v_cvt_pk_bf16_f32 v240, v152, v153
    v_cvt_pk_bf16_f32 v241, v154, v155
    v_mfma_f32_16x16x32_bf16 v[156:159], a[164:167], a[32:35], v[156:159]
    ds_read_b64_tr_b16 a[76:77], v21 offset:29568
    ds_read_b64_tr_b16 a[78:79], v16 offset:29568
    v_mfma_f32_16x16x32_bf16 v[156:159], v[48:51], a[12:15], v[156:159]
    v_mfma_f32_16x16x32_bf16 v[160:163], v[52:55], a[12:15], v[160:163]
    ds_read_b64_tr_b16 a[96:97], v21 offset:34816
    ds_read_b64_tr_b16 a[98:99], v16 offset:34816
    v_mfma_f32_16x16x32_bf16 v[160:163], a[168:171], a[32:35], v[160:163]
    v_mfma_f32_16x16x32_bf16 v[160:163], a[184:187], a[52:55], v[160:163]
    ds_read_b64_tr_b16 a[116:117], v21 offset:43264
    ds_read_b64_tr_b16 a[118:119], v16 offset:43264
    v_mfma_f32_16x16x32_bf16 v[160:163], a[200:203], a[72:75], v[160:163]
    v_cvt_pk_bf16_f32 v242, v156, v157
    v_cvt_pk_bf16_f32 v243, v158, v159
    v_mfma_f32_16x16x32_bf16 v[160:163], a[216:219], a[92:95], v[160:163]
    ds_read_b64_tr_b16 a[136:137], v21 offset:39040
    ds_read_b64_tr_b16 a[138:139], v16 offset:39040
    v_mfma_f32_16x16x32_bf16 v[160:163], v[192:195], a[112:115], v[160:163]
    v_and_b32 v240, -2, v240
    v_and_b32 v242, -2, v242
    v_mfma_f32_16x16x32_bf16 v[160:163], v[208:211], a[132:135], v[160:163]
    ds_read_b64_tr_b16 a[156:157], v21 offset:47488
    ds_read_b64_tr_b16 a[158:159], v16 offset:47488
    v_mfma_f32_16x16x32_bf16 v[160:163], v[68:71], a[152:155], v[160:163]
    buffer_store_dwordx4 v[240:243], v10, s[24:27], 0 offen offset:3072 sc1
    v_mfma_f32_16x16x32_bf16 v[164:167], v[72:75], a[152:155], v[164:167]
    v_mfma_f32_16x16x32_bf16 v[164:167], v[212:215], a[132:135], v[164:167]
    v_mfma_f32_16x16x32_bf16 v[164:167], v[196:199], a[112:115], v[164:167]
    v_mfma_f32_16x16x32_bf16 v[164:167], a[220:223], a[92:95], v[164:167]
    v_mfma_f32_16x16x32_bf16 v[164:167], a[204:207], a[72:75], v[164:167]
    v_mfma_f32_16x16x32_bf16 v[164:167], a[188:191], a[52:55], v[164:167]
    v_cvt_pk_bf16_f32 v244, v160, v161
    v_cvt_pk_bf16_f32 v245, v162, v163
    v_mfma_f32_16x16x32_bf16 v[164:167], a[172:175], a[32:35], v[164:167]
    v_mfma_f32_16x16x32_bf16 v[164:167], v[92:95], a[12:15], v[164:167]
    s_waitcnt lgkmcnt(0)
    v_mfma_f32_16x16x32_bf16 v[168:171], v[44:47], a[16:19], v[168:171]
    v_mfma_f32_16x16x32_bf16 v[168:171], a[160:163], a[36:39], v[168:171]
    v_mfma_f32_16x16x32_bf16 v[168:171], a[176:179], a[56:59], v[168:171]
    v_mfma_f32_16x16x32_bf16 v[168:171], a[192:195], a[76:79], v[168:171]
    v_cvt_pk_bf16_f32 v246, v164, v165
    v_cvt_pk_bf16_f32 v247, v166, v167
    v_mfma_f32_16x16x32_bf16 v[168:171], a[208:211], a[96:99], v[168:171]
    v_and_b32 v244, -2, v244
    v_and_b32 v246, -2, v246
    v_mfma_f32_16x16x32_bf16 v[168:171], v[184:187], a[116:119], v[168:171]
    buffer_store_dwordx4 v[244:247], v10, s[24:27], s50 offen sc1
    v_mfma_f32_16x16x32_bf16 v[168:171], v[200:203], a[136:139], v[168:171]
    v_mfma_f32_16x16x32_bf16 v[168:171], v[60:63], a[156:159], v[168:171]
    v_mfma_f32_16x16x32_bf16 v[172:175], v[64:67], a[156:159], v[172:175]
    v_mfma_f32_16x16x32_bf16 v[172:175], v[204:207], a[136:139], v[172:175]
    v_mfma_f32_16x16x32_bf16 v[172:175], v[188:191], a[116:119], v[172:175]
    v_mfma_f32_16x16x32_bf16 v[172:175], a[212:215], a[96:99], v[172:175]
    v_mfma_f32_16x16x32_bf16 v[172:175], a[196:199], a[76:79], v[172:175]
    v_mfma_f32_16x16x32_bf16 v[172:175], a[180:183], a[56:59], v[172:175]
    v_cvt_pk_bf16_f32 v248, v168, v169
    v_cvt_pk_bf16_f32 v249, v170, v171
    v_mfma_f32_16x16x32_bf16 v[172:175], a[164:167], a[36:39], v[172:175]
    v_mfma_f32_16x16x32_bf16 v[172:175], v[48:51], a[16:19], v[172:175]
    v_mfma_f32_16x16x32_bf16 v[176:179], v[52:55], a[16:19], v[176:179]
    v_mfma_f32_16x16x32_bf16 v[176:179], a[168:171], a[36:39], v[176:179]
    v_mfma_f32_16x16x32_bf16 v[176:179], a[184:187], a[56:59], v[176:179]
    v_mfma_f32_16x16x32_bf16 v[176:179], a[200:203], a[76:79], v[176:179]
    v_cvt_pk_bf16_f32 v250, v172, v173
    v_cvt_pk_bf16_f32 v251, v174, v175
    v_mfma_f32_16x16x32_bf16 v[176:179], a[216:219], a[96:99], v[176:179]
    v_and_b32 v248, -2, v248
    v_and_b32 v250, -2, v250
    v_mfma_f32_16x16x32_bf16 v[176:179], v[192:195], a[116:119], v[176:179]
    buffer_store_dwordx4 v[248:251], v10, s[24:27], s49 offen sc1
    v_mfma_f32_16x16x32_bf16 v[176:179], v[208:211], a[136:139], v[176:179]
    v_mfma_f32_16x16x32_bf16 v[176:179], v[68:71], a[156:159], v[176:179]
    v_mfma_f32_16x16x32_bf16 v[180:183], v[72:75], a[156:159], v[180:183]
    v_mfma_f32_16x16x32_bf16 v[180:183], v[212:215], a[136:139], v[180:183]
    v_mfma_f32_16x16x32_bf16 v[180:183], v[196:199], a[116:119], v[180:183]
    v_mfma_f32_16x16x32_bf16 v[180:183], a[220:223], a[96:99], v[180:183]
    v_mfma_f32_16x16x32_bf16 v[180:183], a[204:207], a[76:79], v[180:183]
    v_mfma_f32_16x16x32_bf16 v[180:183], a[188:191], a[56:59], v[180:183]
    v_mfma_f32_16x16x32_bf16 v[180:183], a[172:175], a[36:39], v[180:183]
    v_mfma_f32_16x16x32_bf16 v[180:183], v[92:95], a[16:19], v[180:183]
    s_buffer_load_dwordx4 s[44:47], s[24:27], s60 glc
    v_cvt_pk_bf16_f32 v252, v176, v177
    v_cvt_pk_bf16_f32 v253, v178, v179
    s_nop 4
    v_cvt_pk_bf16_f32 v254, v180, v181
    v_cvt_pk_bf16_f32 v255, v182, v183
    v_and_b32 v252, -2, v252
    v_and_b32 v254, -2, v254
    buffer_store_dwordx4 v[252:255], v10, s[24:27], s50 offen offset:1024 sc1
    buffer_store_short v17, v37, s[24:27], s65 offen sc1
    s_cmp_lg_u32 s72, 0
    s_cbranch_scc1 L_take
L_pa:
    s_waitcnt lgkmcnt(0)
    s_andn2_b64 exec, s[44:45], s[52:53]
    s_cbranch_scc0 L_sk0
    buffer_load_dwordx4 v[60:63], v32, s[24:27], s56 offen sc1
    buffer_load_dwordx4 v[64:67], v32, s[24:27], s56 offen offset:1024 sc1
    buffer_load_dwordx4 v[68:71], v32, s[24:27], s56 offen offset:2048 sc1
    buffer_load_dwordx4 v[72:75], v32, s[24:27], s56 offen offset:3072 sc1
    buffer_load_dwordx4 v[76:79], v32, s[24:27], s57 offen sc1
    s_or_b64 s[52:53], s[52:53], s[44:45]
L_sk0:
    s_andn2_b64 exec, s[46:47], s[54:55]
    s_cbranch_scc0 L_sk1
    buffer_load_dwordx4 v[80:83], v32, s[24:27], s58 offen sc1
    buffer_load_dwordx4 v[84:87], v32, s[24:27], s58 offen offset:1024 sc1
    buffer_load_dwordx4 v[88:91], v32, s[24:27], s58 offen offset:2048 sc1
    buffer_load_dwordx4 v[92:95], v32, s[24:27], s58 offen offset:3072 sc1
    buffer_load_dwordx4 v[96:99], v32, s[24:27], s59 offen sc1
    s_or_b64 s[54:55], s[54:55], s[46:47]
L_sk1:
    s_mov_b64 exec, -1
    s_and_b64 s[44:45], s[52:53], s[54:55]
    s_cmp_eq_u64 s[44:45], -1
    s_cbranch_scc1 L_pd
L_pn:
    s_buffer_load_dwordx4 s[44:47], s[24:27], s60 glc
    s_add_u32 s39, s39, 0x1000
    s_cbranch_scc0 L_pa
    s_waitcnt lgkmcnt(0)
    v_mov_b32 v40, 0
L_pd:
    s_waitcnt vmcnt(0)
    v_mfma_f32_16x16x32_bf16 v[44:47], v[24:27], v[60:63], 0
    v_or3_b32 v35, v60, v62, v64
    v_or3_b32 v36, v80, v82, v84
    v_mfma_f32_16x16x32_bf16 v[48:51], v[24:27], v[68:71], 0
    v_or3_b32 v35, v35, v66, v68
    v_or3_b32 v36, v36, v86, v88
    v_mfma_f32_16x16x32_bf16 v[52:55], v[24:27], v[76:79], 0
    v_or3_b32 v35, v35, v70, v72
    v_or3_b32 v36, v36, v90, v92
    v_mfma_f32_16x16x32_bf16 v[44:47], v[24:27], v[80:83], v[44:47]
    v_or3_b32 v35, v35, v74, v76
    v_or3_b32 v36, v36, v94, v96
    v_mfma_f32_16x16x32_bf16 v[48:51], v[24:27], v[88:91], v[48:51]
    v_bitop3_b32 v35, v35, v78, v40 bitop3:0xa8
    v_bitop3_b32 v36, v36, v98, v40 bitop3:0xa8
    v_mfma_f32_16x16x32_bf16 v[52:55], v[24:27], v[96:99], v[52:55]
    v_cmp_eq_u32 s[52:53], 0, v35
    v_cmp_eq_u32 s[54:55], 0, v36
    v_mfma_f32_16x16x32_bf16 v[44:47], v[28:31], v[64:67], v[44:47]
    v_mfma_f32_16x16x32_bf16 v[48:51], v[28:31], v[72:75], v[48:51]
    s_and_b64 s[44:45], s[52:53], s[54:55]
    s_cmp_eq_u64 s[44:45], -1
    v_mfma_f32_16x16x32_bf16 v[44:47], v[28:31], v[84:87], v[44:47]
    s_cbranch_scc0 L_pn
    v_mfma_f32_16x16x32_bf16 v[48:51], v[28:31], v[92:95], v[48:51]
    s_cmp_lg_u32 s73, 0
    s_nop 2
    v_cvt_pk_bf16_f32 v104, v52, v53
    v_cvt_pk_bf16_f32 v105, v54, v55
    buffer_store_dwordx2 v[104:105], v34, s[12:15], s63 offen
    s_nop 0
    v_cvt_pk_bf16_f32 v100, v44, v45
    v_cvt_pk_bf16_f32 v101, v46, v47
    v_cvt_pk_bf16_f32 v102, v48, v49
    v_cvt_pk_bf16_f32 v103, v50, v51
    buffer_store_dwordx2 v[100:101], v33, s[12:15], s61 offen
    buffer_store_dwordx2 v[102:103], v33, s[12:15], s62 offen
    s_cbranch_scc1 L_more
L_fin:
L_end:
    s_endpgm
L_ann:
    s_mov_b32 s43, 1
    s_mov_b32 s37, 5
    s_or_b32 s45, s32, s41
    s_cbranch_scc1 L_loop
    s_getreg_b32 s45, hwreg(HW_REG_XCC_ID, 0, 3)
    s_mul_i32 s46, s35, 7
    s_xor_b32 s45, s45, s46
    s_lshl_b32 s45, s45, s67
    v_mov_b32 v235, s45
    buffer_atomic_add_x2 v[234:235], v1, s[4:7], s70 offen sc0 sc1
    s_branch L_loop
L_notyet:
    s_lshr_b32 s46, s45, 16
    s_or_b32 s72, s72, s46
    s_bitcmp1_b32 s45, 0
    s_cbranch_scc1 L_fallback
    v_add_u32 v23, 0, v20
    v_mov_b32 v17, -1
    v_lshlrev_b32 v8, 20, v1
    v_mov_b32 v18, 2
    v_add_u32 v10, 40960, v0
    ds_read_b128 v[216:219], v23
    ds_read_b128 v[220:223], v23 offset:1024
    ds_read_b128 v[224:227], v23 offset:2048
    ds_read_b128 v[228:231], v23 offset:3072
    ds_read_b128 v[232:235], v23 offset:16896
    ds_read_b128 v[236:239], v23 offset:17920
    ds_read_b128 v[240:243], v23 offset:18944
    ds_read_b128 v[244:247], v23 offset:19968
    ds_read_b128 v[248:251], v23 offset:33792
    ds_read_b128 v[252:255], v23 offset:34816
    s_waitcnt vmcnt(0) lgkmcnt(0)
    buffer_store_dwordx4 v[216:219], v0, s[24:27], 0 offen sc1
    buffer_store_dwordx4 v[220:223], v0, s[24:27], s49 offen offset:1024 sc1
    buffer_store_dwordx4 v[224:227], v0, s[24:27], 0 offen offset:1024 sc1
    buffer_store_dwordx4 v[228:231], v0, s[24:27], s49 offen offset:2048 sc1
    buffer_store_dwordx4 v[232:235], v0, s[24:27], 0 offen offset:2048 sc1
    buffer_store_dwordx4 v[236:239], v0, s[24:27], s49 offen offset:3072 sc1
    buffer_store_dwordx4 v[240:243], v0, s[24:27], 0 offen offset:3072 sc1
    buffer_store_dwordx4 v[244:247], v0, s[24:27], s50 offen sc1
    buffer_store_dwordx4 v[248:251], v0, s[24:27], s49 offen sc1
    buffer_store_dwordx4 v[252:255], v0, s[24:27], s50 offen offset:1024 sc1
    buffer_store_dwordx4 v[216:219], v10, s[24:27], 0 offen sc1
    buffer_store_dwordx4 v[220:223], v10, s[24:27], s49 offen offset:1024 sc1
    buffer_store_dwordx4 v[224:227], v10, s[24:27], 0 offen offset:1024 sc1
    buffer_store_dwordx4 v[228:231], v10, s[24:27], s49 offen offset:2048 sc1
    buffer_store_dwordx4 v[232:235], v10, s[24:27], 0 offen offset:2048 sc1
    buffer_store_dwordx4 v[236:239], v10, s[24:27], s49 offen offset:3072 sc1
    buffer_store_dwordx4 v[240:243], v10, s[24:27], 0 offen offset:3072 sc1
    buffer_store_dwordx4 v[244:247], v10, s[24:27], s50 offen sc1
    buffer_store_dwordx4 v[248:251], v10, s[24:27], s49 offen sc1
    buffer_store_dwordx4 v[252:255], v10, s[24:27], s50 offen offset:1024 sc1
    s_waitcnt vmcnt(0)
    buffer_store_dword v18, v8, s[24:27], s66 offen sc1
    s_bitcmp0_b32 s45, 1
    s_cbranch_scc1 L_oph
    s_barrier
    s_cmp_lg_u32 s32, 0
    s_cbranch_scc1 L_ny2
    s_mov_b32 s42, 0x7d0
L_ny0:
    buffer_load_dword v38, v1, s[4:7], s70 offen sc1
    s_waitcnt vmcnt(0)
    v_readfirstlane_b32 s45, v38
    s_nop 0
    s_and_b32 s45, s45, 15
    s_cbranch_scc0 L_ny1
    s_sub_u32 s42, s42, 1
    s_cbranch_scc0 L_ny0
    s_lshl_b32 s45, 0x10000, s71
    v_mov_b32 v38, s45
    buffer_atomic_or v38, v1, s[4:7], s70 offen sc0 sc1
    s_waitcnt vmcnt(0)
    v_readfirstlane_b32 s45, v38
    s_nop 0
    s_and_b32 s45, s45, 15
L_ny1:
    v_mov_b32 v38, s45
    ds_write_b32 v22, v38
    s_waitcnt lgkmcnt(0)
L_ny2:
    s_barrier
    ds_read_b32 v38, v22
    s_waitcnt lgkmcnt(0)
    v_readfirstlane_b32 s45, v38
    s_nop 0
    s_cmp_eq_u32 s45, 0
    s_cbranch_scc1 L_oph
    s_branch L_fin
L_take:
    s_waitcnt lgkmcnt(0)
    s_bitset1_b32 s73, s71
    s_lshl_b32 s45, s34, 19
    s_lshl_b32 s46, s35, 9
    s_add_u32 s45, s45, s46
    s_sub_u32 s20, s20, s45
    s_subb_u32 s21, s21, 0
    s_ff1_i32_b32 s71, s72
    s_bitset0_b32 s72, s71
    s_and_b32 s35, s71, 1
    s_lshr_b32 s34, s71, 1
    s_lshl_b32 s45, s34, 19
    s_lshl_b32 s46, s35, 9
    s_add_u32 s45, s45, s46
    s_add_u32 s20, s20, s45
    s_addc_u32 s21, s21, 0
    s_sub_u32 s22, 0x80000, s46
    s_lshl_b32 s45, s71, 3
    s_add_u32 s45, s45, s32
    s_mul_i32 s45, s45, 0x2800
    v_add_u32 v0, s45, v1
    s_mov_b32 s49, 0x1000
    s_mov_b32 s50, 0x2000
    s_lshl_b32 s65, s35, 2
    s_add_u32 s65, s65, s32
    s_mul_i32 s65, s65, 0x1000
    s_lshl_b32 s45, s34, 1
    s_add_u32 s65, s65, s45
    s_add_u32 s65, s65, 0x140000
    s_mul_i32 s66, s71, 0x800
    s_lshl_b32 s45, s32, 8
    s_add_u32 s66, s66, s45
    s_add_u32 s66, s66, 0x140400
    s_lshl_b32 s52, s35, 18
    s_xor_b32 s53, s52, 0x40000
    s_mov_b32 s39, 0
    v_add_u32 v23, 0, v20
    s_waitcnt vmcnt(0) lgkmcnt(0)
    s_barrier
    s_xor_b32 s54, s66, 0x800
    v_accvgpr_read_b32 v2, a240
    v_accvgpr_read_b32 v3, a241
    v_accvgpr_read_b32 v4, a242
    v_accvgpr_read_b32 v5, a243
    s_add_u32 m0, s40, 0
    s_add_u32 s80, s52, 0x20000
    buffer_load_dwordx4 v2, s[20:23], s80 offen lds
    buffer_load_dwordx4 v3, s[20:23], s80 offen offset:1056 lds
    buffer_load_dwordx4 v4, s[20:23], s80 offen offset:2112 lds
    buffer_load_dwordx4 v5, s[20:23], s80 offen offset:3168 lds
    s_add_u32 m0, s40, 0x4200
    s_add_u32 s80, s52, 0x28000
    buffer_load_dwordx4 v2, s[20:23], s80 offen lds
    buffer_load_dwordx4 v3, s[20:23], s80 offen offset:1056 lds
    buffer_load_dwordx4 v4, s[20:23], s80 offen offset:2112 lds
    buffer_load_dwordx4 v5, s[20:23], s80 offen offset:3168 lds
    s_add_u32 m0, s40, 0x8400
    s_add_u32 s80, s52, 0x30000
    buffer_load_dwordx4 v2, s[20:23], s80 offen lds
    buffer_load_dwordx4 v3, s[20:23], s80 offen offset:1056 lds
    buffer_load_dwordx4 v4, s[20:23], s80 offen offset:2112 lds
    buffer_load_dwordx4 v5, s[20:23], s80 offen offset:3168 lds
    s_add_u32 m0, s40, 0xc600
    s_add_u32 s80, s52, 0x38000
    buffer_load_dwordx4 v2, s[20:23], s80 offen lds
    buffer_load_dwordx4 v3, s[20:23], s80 offen offset:1056 lds
    buffer_load_dwordx4 v4, s[20:23], s80 offen offset:2112 lds
    buffer_load_dwordx4 v5, s[20:23], s80 offen offset:3168 lds
    v_add_u32 v10, 40960, v0
    buffer_load_dwordx4 v[216:219], v10, s[24:27], 0 offen sc1
    buffer_load_dwordx4 v[220:223], v10, s[24:27], s49 offen offset:1024 sc1
    buffer_load_dwordx4 v[224:227], v10, s[24:27], 0 offen offset:1024 sc1
    buffer_load_dwordx4 v[228:231], v10, s[24:27], s49 offen offset:2048 sc1
    buffer_load_dwordx4 v[232:235], v10, s[24:27], 0 offen offset:2048 sc1
    buffer_load_dwordx4 v[236:239], v10, s[24:27], s49 offen offset:3072 sc1
    buffer_load_dwordx4 v[240:243], v10, s[24:27], 0 offen offset:3072 sc1
    buffer_load_dwordx4 v[244:247], v10, s[24:27], s50 offen sc1
    buffer_load_dwordx4 v[248:251], v10, s[24:27], s49 offen sc1
    buffer_load_dwordx4 v[252:255], v10, s[24:27], s50 offen offset:1024 sc1
    s_waitcnt vmcnt(0)
    ds_write_b128 v23, v[216:219]
    ds_write_b128 v23, v[220:223] offset:1024
    ds_write_b128 v23, v[224:227] offset:2048
    ds_write_b128 v23, v[228:231] offset:3072
    ds_write_b128 v23, v[232:235] offset:16896
    ds_write_b128 v23, v[236:239] offset:17920
    ds_write_b128 v23, v[240:243] offset:18944
    ds_write_b128 v23, v[244:247] offset:19968
    ds_write_b128 v23, v[248:251] offset:33792
    ds_write_b128 v23, v[252:255] offset:34816
    s_waitcnt lgkmcnt(0)
    s_barrier
    ds_read_b64_tr_b16 a[160:161], v12
    ds_read_b64_tr_b16 a[162:163], v12 offset:2112
    ds_read_b64_tr_b16 a[164:165], v13
    ds_read_b64_tr_b16 a[166:167], v13 offset:2112
    ds_read_b64_tr_b16 a[168:169], v14
    ds_read_b64_tr_b16 a[170:171], v14 offset:2112
    ds_read_b64_tr_b16 a[172:173], v15
    ds_read_b64_tr_b16 a[174:175], v15 offset:2112
    ds_read_b64_tr_b16 a[176:177], v12 offset:16896
    ds_read_b64_tr_b16 a[178:179], v12 offset:19008
    ds_read_b64_tr_b16 a[180:181], v13 offset:16896
    ds_read_b64_tr_b16 a[182:183], v13 offset:19008
    ds_read_b64_tr_b16 a[184:185], v14 offset:16896
    ds_read_b64_tr_b16 a[186:187], v14 offset:19008
    ds_read_b64_tr_b16 a[188:189], v15 offset:16896
    ds_read_b64_tr_b16 a[190:191], v15 offset:19008
    ds_read_b64_tr_b16 a[192:193], v12 offset:33792
    ds_read_b64_tr_b16 a[194:195], v12 offset:35904
    ds_read_b64_tr_b16 a[196:197], v13 offset:33792
    ds_read_b64_tr_b16 a[198:199], v13 offset:35904
    ds_read_b64_tr_b16 a[200:201], v14 offset:33792
    ds_read_b64_tr_b16 a[202:203], v14 offset:35904
    ds_read_b64_tr_b16 a[204:205], v15 offset:33792
    ds_read_b64_tr_b16 a[206:207], v15 offset:35904
    ds_read_b64_tr_b16 a[208:209], v12 offset:50688
    ds_read_b64_tr_b16 a[210:211], v12 offset:52800
    ds_read_b64_tr_b16 a[212:213], v13 offset:50688
    ds_read_b64_tr_b16 a[214:215], v13 offset:52800
    ds_read_b64_tr_b16 a[216:217], v14 offset:50688
    ds_read_b64_tr_b16 a[218:219], v14 offset:52800
    ds_read_b64_tr_b16 a[220:221], v15 offset:50688
    ds_read_b64_tr_b16 a[222:223], v15 offset:52800
    ds_read_b64_tr_b16 a[0:1], v21 offset:12672
    ds_read_b64_tr_b16 a[2:3], v16 offset:12672
    ds_read_b64_tr_b16 a[4:5], v21 offset:14720
    ds_read_b64_tr_b16 a[6:7], v16 offset:14720
    ds_read_b64_tr_b16 a[8:9], v21 offset:29568
    ds_read_b64_tr_b16 a[10:11], v16 offset:29568
    ds_read_b64_tr_b16 a[12:13], v21 offset:31616
    ds_read_b64_tr_b16 a[14:15], v16 offset:31616
    ds_read_b64_tr_b16 a[16:17], v21 offset:46464
    ds_read_b64_tr_b16 a[18:19], v16 offset:46464
    s_waitcnt lgkmcnt(0)
    s_add_u32 m0, s40, 0
    s_add_u32 s80, s52, 0
    buffer_load_dwordx4 v2, s[20:23], s80 offen lds
    buffer_load_dwordx4 v3, s[20:23], s80 offen offset:1056 lds
    buffer_load_dwordx4 v4, s[20:23], s80 offen offset:2112 lds
    buffer_load_dwordx4 v5, s[20:23], s80 offen offset:3168 lds
    s_add_u32 m0, s40, 0x4200
    s_add_u32 s80, s52, 0x8000
    buffer_load_dwordx4 v2, s[20:23], s80 offen lds
    buffer_load_dwordx4 v3, s[20:23], s80 offen offset:1056 lds
    buffer_load_dwordx4 v4, s[20:23], s80 offen offset:2112 lds
    buffer_load_dwordx4 v5, s[20:23], s80 offen offset:3168 lds
    s_add_u32 m0, s40, 0x8400
    s_add_u32 s80, s52, 0x10000
    buffer_load_dwordx4 v2, s[20:23], s80 offen lds
    buffer_load_dwordx4 v3, s[20:23], s80 offen offset:1056 lds
    buffer_load_dwordx4 v4, s[20:23], s80 offen offset:2112 lds
    buffer_load_dwordx4 v5, s[20:23], s80 offen offset:3168 lds
    s_add_u32 m0, s40, 0xc600
    s_add_u32 s80, s52, 0x18000
    buffer_load_dwordx4 v2, s[20:23], s80 offen lds
    buffer_load_dwordx4 v3, s[20:23], s80 offen offset:1056 lds
    buffer_load_dwordx4 v4, s[20:23], s80 offen offset:2112 lds
    buffer_load_dwordx4 v5, s[20:23], s80 offen offset:3168 lds
    s_waitcnt vmcnt(0)
    s_branch L_oph
L_more:
    s_ff1_i32_b32 s38, s73
    s_bitset0_b32 s73, s38
    s_mul_i32 s60, s38, 0x800
    s_add_u32 s60, s60, 0x140000
    s_lshr_b32 s45, s38, 3
    s_xor_b32 s45, s45, 1
    s_mul_i32 s45, s45, 0x14000
    s_and_b32 s46, s38, 7
    s_mul_i32 s46, s46, 0x1400
    s_add_u32 s56, s45, s46
    s_add_u32 s57, s56, 0x1000
    s_add_u32 s58, s56, 0xa0000
    s_add_u32 s59, s56, 0xa1000
    s_lshl_b32 s61, s38, 6
    s_add_u32 s62, s61, 0x10000
    s_add_u32 s63, s61, 0x20000
    s_mov_b32 s39, 0
    s_mov_b64 s[52:53], 0
    s_mov_b64 s[54:55], 0
    s_waitcnt vmcnt(0)
L_pc2:
    s_buffer_load_dwordx4 s[44:47], s[24:27], s60 glc
L_pb:
    s_waitcnt vmcnt(0)
    s_branch L_pa
L_fallback:
    s_waitcnt vmcnt(0) lgkmcnt(0)
    s_barrier
    s_mov_b32 s41, 1
    s_mov_b32 s8, s28
    s_mov_b32 s9, s29
    s_mov_b32 s12, s30
    s_mov_b32 s13, s31
    s_mov_b32 s42, 0x80060
    s_mov_b32 s10, s42
    s_mov_b32 s14, s42
    s_mov_b32 s39, 0x4000
    s_mov_b32 s38, 0x10000
    s_mov_b32 s37, 0
    s_mov_b32 s43, 0
    s_mov_b64 vcc, 0
    s_mov_b32 s56, s20
    s_mov_b32 s57, s21
    s_mov_b32 s59, 0x20000
    s_mul_i32 s3, s35, 0x1ff
    s_lshl_b32 s45, s33, 6
    s_add_u32 s3, s3, s45
    s_lshl_b32 s3, s3, 9
    s_add_u32 s45, s3, 0x8000
    s_min_u32 s58, s45, s22
    s_mul_i32 s45, s32, 0x500
    s_add_u32 s3, s3, s45
    v_accvgpr_read_b32 v2, a244
    v_accvgpr_read_b32 v3, a245
    v_accvgpr_read_b32 v4, a246
    v_accvgpr_read_b32 v5, a247
    v_mov_b32 v208, 4286578688
    v_mov_b32 v212, 4286578688
    v_mov_b32 v216, 4286578688
    v_mov_b32 v220, 4286578688
    v_mov_b32 v224, 4286578688
    s_and_b32 s45, s32, 1
    s_mul_i32 s45, s45, 0x2100
    v_subrev_u32 v23, s45, v6
    s_mov_b32 s80, 0
    s_add_u32 m0, s40, 0
L_fb_loop:
    s_nop 0
    buffer_load_dwordx4 v2, s[8:11], s80 offen lds
    buffer_load_dwordx4 v3, s[8:11], s80 offen offset:1056 lds
    buffer_load_dwordx4 v4, s[8:11], s80 offen offset:2112 lds
    buffer_load_dwordx4 v5, s[8:11], s80 offen offset:3168 lds
    s_waitcnt vmcnt(0)
    s_barrier
    ds_read_b128 a[160:163], v23
    ds_read_b128 a[164:167], v23 offset:64
    ds_read_b128 a[168:171], v23 offset:128
    ds_read_b128 a[172:175], v23 offset:192
    ds_read_b128 a[176:179], v23 offset:512
    ds_read_b128 a[180:183], v23 offset:576
    ds_read_b128 a[184:187], v23 offset:640
    ds_read_b128 a[188:191], v23 offset:704
    ds_read_b128 a[192:195], v23 offset:8448
    ds_read_b128 a[196:199], v23 offset:8512
    ds_read_b128 a[200:203], v23 offset:8576
    ds_read_b128 a[204:207], v23 offset:8640
    ds_read_b128 a[208:211], v23 offset:8960
    ds_read_b128 a[212:215], v23 offset:9024
    ds_read_b128 a[216:219], v23 offset:9088
    ds_read_b128 a[220:223], v23 offset:9152
    s_waitcnt lgkmcnt(0)
    s_barrier
    v_mfma_f32_16x16x32_bf16 v[168:171], a[160:163], a[80:83], 0
    v_mfma_f32_16x16x32_bf16 v[168:171], a[164:167], a[84:87], v[168:171]
    v_mfma_f32_16x16x32_bf16 v[168:171], a[168:171], a[88:91], v[168:171]
    v_mfma_f32_16x16x32_bf16 v[168:171], a[172:175], a[92:95], v[168:171]
    v_mfma_f32_16x16x32_bf16 v[172:175], a[176:179], a[80:83], 0
    v_mfma_f32_16x16x32_bf16 v[172:175], a[180:183], a[84:87], v[172:175]
    v_mfma_f32_16x16x32_bf16 v[172:175], a[184:187], a[88:91], v[172:175]
    v_mfma_f32_16x16x32_bf16 v[172:175], a[188:191], a[92:95], v[172:175]
    v_mfma_f32_16x16x32_bf16 v[176:179], a[192:195], a[80:83], 0
    v_mfma_f32_16x16x32_bf16 v[176:179], a[196:199], a[84:87], v[176:179]
    v_mfma_f32_16x16x32_bf16 v[176:179], a[200:203], a[88:91], v[176:179]
    v_mfma_f32_16x16x32_bf16 v[176:179], a[204:207], a[92:95], v[176:179]
    v_mfma_f32_16x16x32_bf16 v[180:183], a[208:211], a[80:83], 0
    v_mfma_f32_16x16x32_bf16 v[180:183], a[212:215], a[84:87], v[180:183]
    v_mfma_f32_16x16x32_bf16 v[180:183], a[216:219], a[88:91], v[180:183]
    v_mfma_f32_16x16x32_bf16 v[180:183], a[220:223], a[92:95], v[180:183]
    s_nop 7
    v_max3_f32 v208, v208, v168, v169
    v_max3_f32 v208, v208, v170, v171
    v_max3_f32 v208, v208, v172, v173
    v_max3_f32 v208, v208, v174, v175
    v_max3_f32 v208, v208, v176, v177
    v_max3_f32 v208, v208, v178, v179
    v_max3_f32 v208, v208, v180, v181
    v_max3_f32 v208, v208, v182, v183
    v_mfma_f32_16x16x32_bf16 v[168:171], a[160:163], a[96:99], 0
    v_mfma_f32_16x16x32_bf16 v[168:171], a[164:167], a[100:103], v[168:171]
    v_mfma_f32_16x16x32_bf16 v[168:171], a[168:171], a[104:107], v[168:171]
    v_mfma_f32_16x16x32_bf16 v[168:171], a[172:175], a[108:111], v[168:171]
    v_mfma_f32_16x16x32_bf16 v[172:175], a[176:179], a[96:99], 0
    v_mfma_f32_16x16x32_bf16 v[172:175], a[180:183], a[100:103], v[172:175]
    v_mfma_f32_16x16x32_bf16 v[172:175], a[184:187], a[104:107], v[172:175]
    v_mfma_f32_16x16x32_bf16 v[172:175], a[188:191], a[108:111], v[172:175]
    v_mfma_f32_16x16x32_bf16 v[176:179], a[192:195], a[96:99], 0
    v_mfma_f32_16x16x32_bf16 v[176:179], a[196:199], a[100:103], v[176:179]
    v_mfma_f32_16x16x32_bf16 v[176:179], a[200:203], a[104:107], v[176:179]
    v_mfma_f32_16x16x32_bf16 v[176:179], a[204:207], a[108:111], v[176:179]
    v_mfma_f32_16x16x32_bf16 v[180:183], a[208:211], a[96:99], 0
    v_mfma_f32_16x16x32_bf16 v[180:183], a[212:215], a[100:103], v[180:183]
    v_mfma_f32_16x16x32_bf16 v[180:183], a[216:219], a[104:107], v[180:183]
    v_mfma_f32_16x16x32_bf16 v[180:183], a[220:223], a[108:111], v[180:183]
    s_nop 7
    v_max3_f32 v212, v212, v168, v169
    v_max3_f32 v212, v212, v170, v171
    v_max3_f32 v212, v212, v172, v173
    v_max3_f32 v212, v212, v174, v175
    v_max3_f32 v212, v212, v176, v177
    v_max3_f32 v212, v212, v178, v179
    v_max3_f32 v212, v212, v180, v181
    v_max3_f32 v212, v212, v182, v183
    v_mfma_f32_16x16x32_bf16 v[168:171], a[160:163], a[112:115], 0
    v_mfma_f32_16x16x32_bf16 v[168:171], a[164:167], a[116:119], v[168:171]
    v_mfma_f32_16x16x32_bf16 v[168:171], a[168:171], a[120:123], v[168:171]
    v_mfma_f32_16x16x32_bf16 v[168:171], a[172:175], a[124:127], v[168:171]
    v_mfma_f32_16x16x32_bf16 v[172:175], a[176:179], a[112:115], 0
    v_mfma_f32_16x16x32_bf16 v[172:175], a[180:183], a[116:119], v[172:175]
    v_mfma_f32_16x16x32_bf16 v[172:175], a[184:187], a[120:123], v[172:175]
    v_mfma_f32_16x16x32_bf16 v[172:175], a[188:191], a[124:127], v[172:175]
    v_mfma_f32_16x16x32_bf16 v[176:179], a[192:195], a[112:115], 0
    v_mfma_f32_16x16x32_bf16 v[176:179], a[196:199], a[116:119], v[176:179]
    v_mfma_f32_16x16x32_bf16 v[176:179], a[200:203], a[120:123], v[176:179]
    v_mfma_f32_16x16x32_bf16 v[176:179], a[204:207], a[124:127], v[176:179]
    v_mfma_f32_16x16x32_bf16 v[180:183], a[208:211], a[112:115], 0
    v_mfma_f32_16x16x32_bf16 v[180:183], a[212:215], a[116:119], v[180:183]
    v_mfma_f32_16x16x32_bf16 v[180:183], a[216:219], a[120:123], v[180:183]
    v_mfma_f32_16x16x32_bf16 v[180:183], a[220:223], a[124:127], v[180:183]
    s_nop 7
    v_max3_f32 v216, v216, v168, v169
    v_max3_f32 v216, v216, v170, v171
    v_max3_f32 v216, v216, v172, v173
    v_max3_f32 v216, v216, v174, v175
    v_max3_f32 v216, v216, v176, v177
    v_max3_f32 v216, v216, v178, v179
    v_max3_f32 v216, v216, v180, v181
    v_max3_f32 v216, v216, v182, v183
    v_mfma_f32_16x16x32_bf16 v[168:171], a[160:163], a[128:131], 0
    v_mfma_f32_16x16x32_bf16 v[168:171], a[164:167], a[132:135], v[168:171]
    v_mfma_f32_16x16x32_bf16 v[168:171], a[168:171], a[136:139], v[168:171]
    v_mfma_f32_16x16x32_bf16 v[168:171], a[172:175], a[140:143], v[168:171]
    v_mfma_f32_16x16x32_bf16 v[172:175], a[176:179], a[128:131], 0
    v_mfma_f32_16x16x32_bf16 v[172:175], a[180:183], a[132:135], v[172:175]
    v_mfma_f32_16x16x32_bf16 v[172:175], a[184:187], a[136:139], v[172:175]
    v_mfma_f32_16x16x32_bf16 v[172:175], a[188:191], a[140:143], v[172:175]
    v_mfma_f32_16x16x32_bf16 v[176:179], a[192:195], a[128:131], 0
    v_mfma_f32_16x16x32_bf16 v[176:179], a[196:199], a[132:135], v[176:179]
    v_mfma_f32_16x16x32_bf16 v[176:179], a[200:203], a[136:139], v[176:179]
    v_mfma_f32_16x16x32_bf16 v[176:179], a[204:207], a[140:143], v[176:179]
    v_mfma_f32_16x16x32_bf16 v[180:183], a[208:211], a[128:131], 0
    v_mfma_f32_16x16x32_bf16 v[180:183], a[212:215], a[132:135], v[180:183]
    v_mfma_f32_16x16x32_bf16 v[180:183], a[216:219], a[136:139], v[180:183]
    v_mfma_f32_16x16x32_bf16 v[180:183], a[220:223], a[140:143], v[180:183]
    s_nop 7
    v_max3_f32 v220, v220, v168, v169
    v_max3_f32 v220, v220, v170, v171
    v_max3_f32 v220, v220, v172, v173
    v_max3_f32 v220, v220, v174, v175
    v_max3_f32 v220, v220, v176, v177
    v_max3_f32 v220, v220, v178, v179
    v_max3_f32 v220, v220, v180, v181
    v_max3_f32 v220, v220, v182, v183
    v_mfma_f32_16x16x32_bf16 v[168:171], a[160:163], a[144:147], 0
    v_mfma_f32_16x16x32_bf16 v[168:171], a[164:167], a[148:151], v[168:171]
    v_mfma_f32_16x16x32_bf16 v[168:171], a[168:171], a[152:155], v[168:171]
    v_mfma_f32_16x16x32_bf16 v[168:171], a[172:175], a[156:159], v[168:171]
    v_mfma_f32_16x16x32_bf16 v[172:175], a[176:179], a[144:147], 0
    v_mfma_f32_16x16x32_bf16 v[172:175], a[180:183], a[148:151], v[172:175]
    v_mfma_f32_16x16x32_bf16 v[172:175], a[184:187], a[152:155], v[172:175]
    v_mfma_f32_16x16x32_bf16 v[172:175], a[188:191], a[156:159], v[172:175]
    v_mfma_f32_16x16x32_bf16 v[176:179], a[192:195], a[144:147], 0
    v_mfma_f32_16x16x32_bf16 v[176:179], a[196:199], a[148:151], v[176:179]
    v_mfma_f32_16x16x32_bf16 v[176:179], a[200:203], a[152:155], v[176:179]
    v_mfma_f32_16x16x32_bf16 v[176:179], a[204:207], a[156:159], v[176:179]
    v_mfma_f32_16x16x32_bf16 v[180:183], a[208:211], a[144:147], 0
    v_mfma_f32_16x16x32_bf16 v[180:183], a[212:215], a[148:151], v[180:183]
    v_mfma_f32_16x16x32_bf16 v[180:183], a[216:219], a[152:155], v[180:183]
    v_mfma_f32_16x16x32_bf16 v[180:183], a[220:223], a[156:159], v[180:183]
    s_nop 7
    v_max3_f32 v224, v224, v168, v169
    v_max3_f32 v224, v224, v170, v171
    v_max3_f32 v224, v224, v172, v173
    v_max3_f32 v224, v224, v174, v175
    v_max3_f32 v224, v224, v176, v177
    v_max3_f32 v224, v224, v178, v179
    v_max3_f32 v224, v224, v180, v181
    v_max3_f32 v224, v224, v182, v183
    s_add_u32 s80, s80, 0x4000
    s_cmp_lt_u32 s80, 0x80000
    s_cbranch_scc1 L_fb_loop
    v_mov_b32 v209, v208
    v_mov_b32 v213, v212
    v_mov_b32 v217, v216
    v_mov_b32 v221, v220
    v_mov_b32 v225, v224
    v_permlane16_swap_b32 v208, v209
    v_permlane16_swap_b32 v212, v213
    v_permlane16_swap_b32 v216, v217
    v_permlane16_swap_b32 v220, v221
    v_permlane16_swap_b32 v224, v225
    v_max_f32 v208, v208, v209
    v_max_f32 v212, v212, v213
    v_max_f32 v216, v216, v217
    v_max_f32 v220, v220, v221
    v_max_f32 v224, v224, v225
    v_mov_b32 v209, v208
    v_mov_b32 v213, v212
    v_mov_b32 v217, v216
    v_mov_b32 v221, v220
    v_mov_b32 v225, v224
    v_permlane32_swap_b32 v208, v209
    v_permlane32_swap_b32 v212, v213
    v_permlane32_swap_b32 v216, v217
    v_permlane32_swap_b32 v220, v221
    v_permlane32_swap_b32 v224, v225
    v_max_f32 v208, v208, v209
    v_max_f32 v212, v212, v213
    v_max_f32 v216, v216, v217
    v_max_f32 v220, v220, v221
    v_max_f32 v224, v224, v225
    v_mul_f32 v211, -1.0, v208
    v_mul_f32 v210, -1.0, v208
    v_mul_f32 v209, -1.0, v208
    v_mul_f32 v208, -1.0, v208
    v_mul_f32 v215, -1.0, v212
    v_mul_f32 v214, -1.0, v212
    v_mul_f32 v213, -1.0, v212
    v_mul_f32 v212, -1.0, v212
    v_mul_f32 v219, -1.0, v216
    v_mul_f32 v218, -1.0, v216
    v_mul_f32 v217, -1.0, v216
    v_mul_f32 v216, -1.0, v216
    v_mul_f32 v223, -1.0, v220
    v_mul_f32 v222, -1.0, v220
    v_mul_f32 v221, -1.0, v220
    v_mul_f32 v220, -1.0, v220
    v_mul_f32 v227, -1.0, v224
    v_mul_f32 v226, -1.0, v224
    v_mul_f32 v225, -1.0, v224
    v_mul_f32 v224, -1.0, v224
    s_add_u32 m0, s40, 0
    s_mov_b32 s80, 0
    buffer_load_dwordx4 v2, s[8:11], s80 offen nt lds
    buffer_load_dwordx4 v3, s[8:11], s80 offen offset:1056 nt lds
    buffer_load_dwordx4 v4, s[8:11], s80 offen offset:2112 nt lds
    buffer_load_dwordx4 v5, s[8:11], s80 offen offset:3168 nt lds
    s_add_u32 m0, s40, 0x4200
    s_mov_b32 s80, 0
    buffer_load_dwordx4 v2, s[12:15], s80 offen nt lds
    buffer_load_dwordx4 v3, s[12:15], s80 offen offset:1056 nt lds
    buffer_load_dwordx4 v4, s[12:15], s80 offen offset:2112 nt lds
    buffer_load_dwordx4 v5, s[12:15], s80 offen offset:3168 nt lds
    s_add_u32 m0, s40, 0x8400
    s_mov_b32 s80, 0x4000
    buffer_load_dwordx4 v2, s[8:11], s80 offen nt lds
    buffer_load_dwordx4 v3, s[8:11], s80 offen offset:1056 nt lds
    buffer_load_dwordx4 v4, s[8:11], s80 offen offset:2112 nt lds
    buffer_load_dwordx4 v5, s[8:11], s80 offen offset:3168 nt lds
    s_add_u32 m0, s40, 0xc600
    s_mov_b32 s80, 0x4000
    buffer_load_dwordx4 v2, s[12:15], s80 offen nt lds
    buffer_load_dwordx4 v3, s[12:15], s80 offen offset:1056 nt lds
    buffer_load_dwordx4 v4, s[12:15], s80 offen offset:2112 nt lds
    buffer_load_dwordx4 v5, s[12:15], s80 offen offset:3168 nt lds
    s_add_u32 m0, s40, 0x10800
    s_mov_b32 s80, 0x8000
    buffer_load_dwordx4 v2, s[8:11], s80 offen nt lds
    buffer_load_dwordx4 v3, s[8:11], s80 offen offset:1056 nt lds
    buffer_load_dwordx4 v4, s[8:11], s80 offen offset:2112 nt lds
    buffer_load_dwordx4 v5, s[8:11], s80 offen offset:3168 nt lds
    s_add_u32 m0, s40, 0x14a00
    s_mov_b32 s80, 0x8000
    buffer_load_dwordx4 v2, s[12:15], s80 offen nt lds
    buffer_load_dwordx4 v3, s[12:15], s80 offen offset:1056 nt lds
    buffer_load_dwordx4 v4, s[12:15], s80 offen offset:2112 nt lds
    buffer_load_dwordx4 v5, s[12:15], s80 offen offset:3168 nt lds
    s_add_u32 m0, s40, 0x18c00
    s_mov_b32 s80, 0xc000
    buffer_load_dwordx4 v2, s[8:11], s80 offen nt lds
    buffer_load_dwordx4 v3, s[8:11], s80 offen offset:1056 nt lds
    buffer_load_dwordx4 v4, s[8:11], s80 offen offset:2112 nt lds
    buffer_load_dwordx4 v5, s[8:11], s80 offen offset:3168 nt lds
    s_add_u32 m0, s40, 0x1ce00
    s_mov_b32 s80, 0xc000
    buffer_load_dwordx4 v2, s[12:15], s80 offen nt lds
    buffer_load_dwordx4 v3, s[12:15], s80 offen offset:1056 nt lds
    buffer_load_dwordx4 v4, s[12:15], s80 offen offset:2112 nt lds
    buffer_load_dwordx4 v5, s[12:15], s80 offen offset:3168 nt lds
    v_mov_b32 v24, 0
    v_mov_b32 v25, 0
    v_mov_b32 v26, 0
    v_mov_b32 v27, 0
    v_mov_b32 v28, 0
    v_mov_b32 v29, 0
    v_mov_b32 v30, 0
    v_mov_b32 v31, 0
    v_mov_b32 v32, 0
    v_mov_b32 v33, 0
    v_mov_b32 v34, 0
    v_mov_b32 v35, 0
    v_mov_b32 v36, 0
    v_mov_b32 v37, 0
    v_mov_b32 v38, 0
    v_mov_b32 v39, 0
    v_mov_b32 v40, 0
    v_mov_b32 v41, 0
    v_mov_b32 v42, 0
    v_mov_b32 v43, 0
    v_mov_b32 v44, 0
    v_mov_b32 v45, 0
    v_mov_b32 v46, 0
    v_mov_b32 v47, 0
    v_mov_b32 v48, 0
    v_mov_b32 v49, 0
    v_mov_b32 v50, 0
    v_mov_b32 v51, 0
    v_mov_b32 v52, 0
    v_mov_b32 v53, 0
    v_mov_b32 v54, 0
    v_mov_b32 v55, 0
    v_mov_b32 v56, 0
    v_mov_b32 v57, 0
    v_mov_b32 v58, 0
    v_mov_b32 v59, 0
    v_mov_b32 v60, 0
    v_mov_b32 v61, 0
    v_mov_b32 v62, 0
    v_mov_b32 v63, 0
    v_mov_b32 v64, 0
    v_mov_b32 v65, 0
    v_mov_b32 v66, 0
    v_mov_b32 v67, 0
    v_mov_b32 v68, 0
    v_mov_b32 v69, 0
    v_mov_b32 v70, 0
    v_mov_b32 v71, 0
    v_mov_b32 v72, 0
    v_mov_b32 v73, 0
    v_mov_b32 v74, 0
    v_mov_b32 v75, 0
    v_mov_b32 v76, 0
    v_mov_b32 v77, 0
    v_mov_b32 v78, 0
    v_mov_b32 v79, 0
    v_mov_b32 v80, 0
    v_mov_b32 v81, 0
    v_mov_b32 v82, 0
    v_mov_b32 v83, 0
    v_mov_b32 v84, 0
    v_mov_b32 v85, 0
    v_mov_b32 v86, 0
    v_mov_b32 v87, 0
    v_mov_b32 v88, 0
    v_mov_b32 v89, 0
    v_mov_b32 v90, 0
    v_mov_b32 v91, 0
    v_mov_b32 v92, 0
    v_mov_b32 v93, 0
    v_mov_b32 v94, 0
    v_mov_b32 v95, 0
    v_mov_b32 v96, 0
    v_mov_b32 v97, 0
    v_mov_b32 v98, 0
    v_mov_b32 v99, 0
    v_mov_b32 v100, 0
    v_mov_b32 v101, 0
    v_mov_b32 v102, 0
    v_mov_b32 v103, 0
    v_accvgpr_write_b32 a0, 0
    v_accvgpr_write_b32 a1, 0
    v_accvgpr_write_b32 a2, 0
    v_accvgpr_write_b32 a3, 0
    v_accvgpr_write_b32 a4, 0
    v_accvgpr_write_b32 a5, 0
    v_accvgpr_write_b32 a6, 0
    v_accvgpr_write_b32 a7, 0
    v_accvgpr_write_b32 a8, 0
    v_accvgpr_write_b32 a9, 0
    v_accvgpr_write_b32 a10, 0
    v_accvgpr_write_b32 a11, 0
    v_accvgpr_write_b32 a12, 0
    v_accvgpr_write_b32 a13, 0
    v_accvgpr_write_b32 a14, 0
    v_accvgpr_write_b32 a15, 0
    v_accvgpr_write_b32 a16, 0
    v_accvgpr_write_b32 a17, 0
    v_accvgpr_write_b32 a18, 0
    v_accvgpr_write_b32 a19, 0
    v_accvgpr_write_b32 a20, 0
    v_accvgpr_write_b32 a21, 0
    v_accvgpr_write_b32 a22, 0
    v_accvgpr_write_b32 a23, 0
    v_accvgpr_write_b32 a24, 0
    v_accvgpr_write_b32 a25, 0
    v_accvgpr_write_b32 a26, 0
    v_accvgpr_write_b32 a27, 0
    v_accvgpr_write_b32 a28, 0
    v_accvgpr_write_b32 a29, 0
    v_accvgpr_write_b32 a30, 0
    v_accvgpr_write_b32 a31, 0
    v_accvgpr_write_b32 a32, 0
    v_accvgpr_write_b32 a33, 0
    v_accvgpr_write_b32 a34, 0
    v_accvgpr_write_b32 a35, 0
    v_accvgpr_write_b32 a36, 0
    v_accvgpr_write_b32 a37, 0
    v_accvgpr_write_b32 a38, 0
    v_accvgpr_write_b32 a39, 0
    v_accvgpr_write_b32 a40, 0
    v_accvgpr_write_b32 a41, 0
    v_accvgpr_write_b32 a42, 0
    v_accvgpr_write_b32 a43, 0
    v_accvgpr_write_b32 a44, 0
    v_accvgpr_write_b32 a45, 0
    v_accvgpr_write_b32 a46, 0
    v_accvgpr_write_b32 a47, 0
    v_accvgpr_write_b32 a48, 0
    v_accvgpr_write_b32 a49, 0
    v_accvgpr_write_b32 a50, 0
    v_accvgpr_write_b32 a51, 0
    v_accvgpr_write_b32 a52, 0
    v_accvgpr_write_b32 a53, 0
    v_accvgpr_write_b32 a54, 0
    v_accvgpr_write_b32 a55, 0
    v_accvgpr_write_b32 a56, 0
    v_accvgpr_write_b32 a57, 0
    v_accvgpr_write_b32 a58, 0
    v_accvgpr_write_b32 a59, 0
    v_accvgpr_write_b32 a60, 0
    v_accvgpr_write_b32 a61, 0
    v_accvgpr_write_b32 a62, 0
    v_accvgpr_write_b32 a63, 0
    v_accvgpr_write_b32 a64, 0
    v_accvgpr_write_b32 a65, 0
    v_accvgpr_write_b32 a66, 0
    v_accvgpr_write_b32 a67, 0
    v_accvgpr_write_b32 a68, 0
    v_accvgpr_write_b32 a69, 0
    v_accvgpr_write_b32 a70, 0
    v_accvgpr_write_b32 a71, 0
    v_accvgpr_write_b32 a72, 0
    v_accvgpr_write_b32 a73, 0
    v_accvgpr_write_b32 a74, 0
    v_accvgpr_write_b32 a75, 0
    v_accvgpr_write_b32 a76, 0
    v_accvgpr_write_b32 a77, 0
    v_accvgpr_write_b32 a78, 0
    v_accvgpr_write_b32 a79, 0
    v_mov_b32 v136, 0
    v_mov_b32 v137, 0
    v_mov_b32 v138, 0
    v_mov_b32 v139, 0
    v_mov_b32 v140, 0
    v_mov_b32 v141, 0
    v_mov_b32 v142, 0
    v_mov_b32 v143, 0
    v_mov_b32 v144, 0
    v_mov_b32 v145, 0
    v_mov_b32 v146, 0
    v_mov_b32 v147, 0
    v_mov_b32 v148, 0
    v_mov_b32 v149, 0
    v_mov_b32 v150, 0
    v_mov_b32 v151, 0
    v_mov_b32 v152, 0
    v_mov_b32 v153, 0
    v_mov_b32 v154, 0
    v_mov_b32 v155, 0
    v_mov_b32 v156, 0
    v_mov_b32 v157, 0
    v_mov_b32 v158, 0
    v_mov_b32 v159, 0
    v_mov_b32 v160, 0
    v_mov_b32 v161, 0
    v_mov_b32 v162, 0
    v_mov_b32 v163, 0
    v_mov_b32 v164, 0
    v_mov_b32 v165, 0
    v_mov_b32 v166, 0
    v_mov_b32 v167, 0
    v_mov_b32 v192, 4048155338
    v_mov_b32 v193, 4048155338
    v_mov_b32 v194, 4048155338
    v_mov_b32 v195, 4048155338
    v_mov_b32 v196, 4048155338
    v_mov_b32 v197, 4048155338
    v_mov_b32 v198, 4048155338
    v_mov_b32 v199, 4048155338
    v_mov_b32 v200, 0
    v_mov_b32 v201, 0
    v_mov_b32 v202, 0
    v_mov_b32 v203, 0
    v_mov_b32 v240, 0
    v_mov_b32 v241, 0
    v_mov_b32 v242, 0
    v_mov_b32 v243, 0
    v_bfe_u32 v16, v1, 4, 1
    v_mul_u32_u24 v16, 43690, v16
    v_add_u32 v16, 17476, v16
    v_mov_b32 v234, 1
    v_mov_b32 v236, 0
    v_mov_b32 v237, 2004318071
    v_lshrrev_b32 v231, 2, v1
    v_mul_u32_u24 v231, 5, v231
    s_waitcnt vmcnt(0)
    s_barrier
    ds_read_b128 a[160:163], v6
    ds_read_b128 a[164:167], v6 offset:64
    ds_read_b128 a[168:171], v6 offset:128
    ds_read_b128 a[172:175], v6 offset:192
    ds_read_b128 a[176:179], v6 offset:512
    ds_read_b128 a[180:183], v6 offset:576
    ds_read_b128 a[184:187], v6 offset:640
    ds_read_b128 a[188:191], v6 offset:704
    ds_read_b64_tr_b16 v[104:105], v8 offset:16896
    ds_read_b64_tr_b16 v[106:107], v8 offset:17408
    ds_read_b64_tr_b16 v[108:109], v8 offset:16928
    ds_read_b64_tr_b16 v[110:111], v8 offset:17440
    ds_read_b64_tr_b16 v[112:113], v8 offset:16960
    ds_read_b64_tr_b16 v[114:115], v8 offset:17472
    ds_read_b64_tr_b16 v[116:117], v8 offset:16992
    ds_read_b64_tr_b16 v[118:119], v8 offset:17504
    ds_read_b64_tr_b16 v[120:121], v10 offset:16896
    ds_read_b64_tr_b16 v[122:123], v10 offset:17408
    ds_read_b64_tr_b16 v[124:125], v10 offset:16928
    ds_read_b64_tr_b16 v[126:127], v10 offset:17440
    ds_read_b64_tr_b16 v[128:129], v10 offset:16960
    ds_read_b64_tr_b16 v[130:131], v10 offset:17472
    ds_read_b64_tr_b16 v[132:133], v10 offset:16992
    ds_read_b64_tr_b16 v[134:135], v10 offset:17504
    s_waitcnt lgkmcnt(0)
    s_barrier
L_loop_in:
    s_add_u32 m0, s40, 0
    v_mfma_f32_16x16x32_bf16 v[168:171], a[160:163], a[80:83], v[208:211]
    v_exp_f32 v192, v192
    v_mfma_f32_16x16x32_bf16 v[168:171], a[164:167], a[84:87], v[168:171]
    s_branch L_loop_mid
L_code_end:
.section .rodata,"a"
.p2align 6
.amdhsa_kernel concat_heads__gqa_block_cached__gqa_block_cached__near_ridge_kernel
  .amdhsa_next_free_vgpr 512
  .amdhsa_next_free_sgpr 102
  .amdhsa_accum_offset 256
  .amdhsa_group_segment_fixed_size 0
  .amdhsa_kernarg_size 104
  .amdhsa_user_sgpr_count 2
  .amdhsa_user_sgpr_kernarg_segment_ptr 1
  .amdhsa_system_sgpr_workgroup_id_x 1
.end_amdhsa_kernel
```
